```python
import torch

def _softmax(x, axis=-1):
    return torch.softmax(x, dim=axis)

def _gelu(x):
    return torch.nn.functional.gelu(x, approximate='tanh')

def _silu(x):
    return torch.nn.functional.silu(x)

def _sigmoid(x):
    return torch.sigmoid(x)

def _layernorm(x, axis=-1, eps=1e-05):
    m = x.mean(dim=axis, keepdim=True)
    v = x.var(dim=axis, keepdim=True, unbiased=False)
    return (x - m) / torch.sqrt(v + eps)

def _scatter_add(tgt, idx, src, axis=0):
    return tgt.clone().index_add_(axis, idx, src)

def _segment_sum(src, seg, n):
    out = torch.zeros((n,) + src.shape[1:], dtype=src.dtype)
    return out.index_add_(0, seg, src)

def _pad(x, pw):
    flat = tuple((v for pair in reversed(pw) for v in pair))
    return torch.nn.functional.pad(x, flat)
kernel_name = 'recurrent_scan__sliding_local_dilated__mixer_gmlp__prompt'

def setup_inputs():

    _w = lambda a: (lambda t: t.to(torch.bfloat16) if t.is_floating_point() else t)(torch.as_tensor(a))

    def _A_setup():
        B, S, D = (1, 2048, 640)
        return {'x': _w((lambda *s: torch.randn(*s, dtype=torch.bfloat16) * 0.05)(B, S, D)), 'wqkv': _w((lambda *s: torch.randn(*s, dtype=torch.bfloat16) * 0.05)(D, 3 * D)), 'wo': _w((lambda *s: torch.randn(*s, dtype=torch.bfloat16) * 0.05)(D, D))}
    _A_in = _A_setup()

    def _B_setup():
        B, S, D, F = (1, 2048, 640, 1728)
        Fh = F // 2
        return {'x': _w((lambda *s: torch.randn(*s, dtype=torch.bfloat16) * 0.05)(B, S, D)), 'w_in': _w((lambda *s: torch.randn(*s, dtype=torch.bfloat16) * 0.4)(D, 2 * Fh)), 'w_sp': _w(0.01 * (lambda *s: torch.randn(*s, dtype=torch.bfloat16) * 0.4)(S, S)), 'b_sp': _w(1.0 + 0.01 * (lambda *s: torch.randn(*s, dtype=torch.bfloat16) * 0.05)(S)), 'w_out': _w((lambda *s: torch.randn(*s, dtype=torch.bfloat16) * 0.05)(Fh, D))}
    _B_in = _B_setup()
    return {'A_x': _A_in['x'], 'A_wqkv': _A_in['wqkv'], 'A_wo': _A_in['wo'], 'B_x': _B_in['x'], 'B_w_in': _B_in['w_in'], 'B_w_sp': _B_in['w_sp'], 'B_b_sp': _B_in['b_sp'], 'B_w_out': _B_in['w_out']}

def reference(A_x, A_wqkv, A_wo, B_x, B_w_in, B_w_sp, B_b_sp, B_w_out):

    def _A_ref(x, wqkv, wo):
        B, S, D = x.shape
        H = 32
        Dh = D // H
        W, dil = (8, 2)
        qkv = (lambda x, *d: x.permute(*d))((x @ wqkv).reshape(B, S, 3, H, Dh), 2, 0, 3, 1, 4)
        q, k, v = (qkv[0], qkv[1], qkv[2])
        scale = Dh ** (-0.5)
        pos = torch.arange(S)
        off = torch.arange(W) * dil
        idx = pos[:, None] - off[None, :]
        mask = idx >= 0
        idx_c = torch.where(mask, idx, 0).reshape(-1)
        kg = k[:, :, idx_c, :].reshape(B, H, S, W, Dh)
        vg = v[:, :, idx_c, :].reshape(B, H, S, W, Dh)
        logits = torch.einsum('bhsd,bhswd->bhsw', q, kg) * scale
        logits = torch.where(mask[None, None, :, :], logits, -1000000000.0)
        attn = _softmax(logits, axis=-1)
        o = torch.einsum('bhsw,bhswd->bhsd', attn, vg)
        return (lambda x, *d: x.permute(*d))(o, 0, 2, 1, 3).reshape(B, S, D) @ wo

    def _B_ref(x, w_in, w_sp, b_sp, w_out):
        B, S, D = x.shape
        F = w_in.shape[-1]
        Fh = F // 2
        z = _gelu(torch.einsum('bsd,df->bsf', x, w_in))
        z1 = z[..., :Fh].clone()
        z2 = _layernorm(z[..., Fh:], axis=-1)
        g = torch.einsum('ts,bsf->btf', w_sp, z2) + b_sp[None, :, None]
        return torch.einsum('bsf,fd->bsd', z1 * g, w_out)
    x = A_x
    xn = _layernorm(x, axis=-1)
    s = _A_ref(xn, A_wqkv, A_wo)
    g = _silu(_B_ref(xn, B_w_in, B_w_sp, B_b_sp, B_w_out))
    return x + s * g
```

```asm
; @launch kernel=p1x_kernel grid=(256,1,1) block=(512,1,1) lds=151552
; @launch kernel=k2_kernel grid=(256,1,1) block=(512,1,1) lds=163840
.amdgcn_target "amdgcn-amd-amdhsa--gfx950"
.text
.globl p1x_kernel
.p2align 8
.type p1x_kernel,@function
p1x_kernel:
  s_cmp_ge_u32 s2, 256
  s_cbranch_scc1 p1x_kernel_end
  s_load_dwordx2 s[16:17], s[0:1], 80
  s_load_dwordx2 s[4:5], s[0:1], 0
  s_load_dwordx2 s[8:9], s[0:1], 32
  s_load_dwordx2 s[12:13], s[0:1], 8
  s_load_dwordx2 s[20:21], s[0:1], 72
  s_load_dwordx2 s[64:65], s[0:1], 40
  s_memrealtime s[60:61]
  v_lshrrev_b32 v16, 6, v0
  v_and_b32 v1, 63, v0
  v_readfirstlane_b32 s28, v16
  s_getpc_b64 s[52:53]
  s_and_b32 s52, s52, 0xffffff00
  v_lshlrev_b32 v16, 7, v0
  s_cmp_lt_u32 s2, 8
  s_cselect_b64 exec, -1, 1
  v_min_u32 v17, 38140, v16
  global_load_dword v211, v17, s[52:53]
  s_mov_b64 exec, -1
  s_and_b32 s33, s2, 7
  s_lshr_b32 s34, s2, 3
  s_and_b32 s29, s33, 1
  s_lshl_b32 s29, s29, 3
  s_and_b32 s35, s34, 7
  s_add_u32 s29, s29, s35
  s_lshr_b32 s30, s33, 1
  s_lshl_b32 s30, s30, 2
  s_lshr_b32 s35, s34, 3
  s_add_u32 s30, s30, s35
  s_lshl_b32 s44, s29, 7
  s_lshl_b32 s33, s30, 3
  s_add_u32 s44, s44, s33
  s_add_u32 s44, s44, s28
  s_mul_i32 s41, s44, 1280
  s_lshl_b32 s44, s44, 4
  s_add_u32 s44, s44, 15204352
  v_min_u32 v15, 1, v1
  v_lshlrev_b32 v15, 31, v15
  s_cmp_eq_u32 s28, 0
  s_cselect_b32 s33, 0, 0x80000000
  v_or_b32 v240, s33, v15
  s_cmp_eq_u32 s2, 0
  s_cselect_b32 s33, 0, 0x80000000
  v_or_b32 v210, s33, v240
  v_lshlrev_b32 v234, 2, v1
  s_cmp_eq_u32 s30, 15
  s_cbranch_scc1 P1_aux
  s_and_b32 s31, s28, 3
  s_lshr_b32 s32, s28, 2
  s_min_u32 s36, s30, 13
  s_add_u32 s37, s30, 14
  s_cmp_lt_u32 s30, 13
  s_cselect_b32 s37, s37, 13
  v_lshrrev_b32 v22, 4, v1
  v_and_b32 v23, 7, v1
  v_xor_b32 v22, v22, v23
  v_lshlrev_b32 v22, 4, v22
  v_lshrrev_b32 v23, 3, v1
  v_mul_u32_u24 v20, 1280, v23
  v_add_u32 v80, v22, v20
  v_xor_b32 v81, 64, v22
  v_add_u32 v81, v81, v20
  v_add_u32 v81, 9216, v81
  v_lshrrev_b32 v22, 2, v1
  v_and_b32 v22, 4, v22
  v_and_b32 v21, 7, v1
  v_xor_b32 v22, v22, v21
  v_lshlrev_b32 v22, 4, v22
  v_mul_u32_u24 v20, 3456, v23
  v_add_u32 v4, v22, v20
  v_mul_u32_u24 v20, 3840, v23
  v_add_u32 v5, v22, v20
  s_lshl_b32 s33, s29, 7
  s_lshl_b32 s34, s28, 4
  s_add_u32 s33, s33, s34
  s_mul_i32 s38, s33, 1280
  s_cmp_eq_u32 s32, 0
  s_cselect_b32 s33, s36, s37
  s_lshl_b32 s33, s33, 7
  s_mul_i32 s34, s31, 55296
  s_add_u32 s39, s33, s34
  s_add_u32 s40, s39, 26624
  s_lshl_b32 s50, s28, 11
  v_mov_b32 v204, 0
  s_waitcnt lgkmcnt(0)
  s_mov_b32 s6, 0x280000
  s_mov_b32 s7, 0x00020000
  s_mov_b32 s10, 0x21c000
  s_mov_b32 s11, 0x00020000
  s_mov_b32 s14, 0x258000
  s_mov_b32 s15, 0x00020000
  s_mov_b32 s18, 0x2000000
  s_mov_b32 s19, 0x00020000
  s_mov_b32 s22, 0x100
  s_mov_b32 s23, 0x00020000
  s_or_b32 s60, s60, 1
  v_mov_b32 v208, s60
  v_mov_b32 v209, s61
  buffer_store_dwordx2 v[208:209], v210, s[20:23], 0 offen sc1
  s_mov_b32 s52, 14221312
  buffer_store_dwordx2 v[208:209], v210, s[16:19], s52 offen
  buffer_load_dwordx2 v[204:205], v240, s[20:23], 0 offen sc1
  s_add_u32 m0, s50, 0
  s_nop 0
  buffer_load_dwordx4 v80, s[4:7], s38 offen lds
  buffer_load_dwordx4 v81, s[4:7], s38 offen offset:1024 lds
  s_add_u32 s38, s38, 128
  s_add_u32 m0, s50, 65536
  s_nop 0
  buffer_load_dwordx4 v4, s[8:11], s39 offen lds
  buffer_load_dwordx4 v4, s[8:11], s40 offen offset:1024 lds
  s_add_u32 s39, s39, 221184
  s_add_u32 s40, s40, 221184
  v_and_b32 v16, 31, v1
  v_lshrrev_b32 v17, 1, v16
  v_and_b32 v17, 7, v17
  v_lshrrev_b32 v20, 5, v1
  v_xor_b32 v17, v17, v20
  v_lshlrev_b32 v17, 4, v17
  v_lshlrev_b32 v16, 7, v16
  v_add_u32 v16, v16, v17
  s_lshl_b32 s33, s31, 12
  v_add_u32 v76, s33, v16
  v_xor_b32 v77, 32, v76
  v_xor_b32 v78, 64, v76
  v_xor_b32 v79, 96, v76
  v_lshrrev_b32 v16, 5, v1
  v_lshlrev_b32 v16, 3, v16
  v_bfe_u32 v17, v1, 2, 2
  v_add_u32 v16, v16, v17
  v_lshlrev_b32 v16, 7, v16
  v_lshrrev_b32 v17, 1, v17
  v_lshlrev_b32 v17, 6, v17
  v_bfe_u32 v20, v1, 4, 1
  v_lshlrev_b32 v20, 5, v20
  v_and_b32 v21, 3, v1
  v_lshlrev_b32 v21, 3, v21
  v_add_u32 v20, v20, v21
  s_lshl_b32 s33, s32, 6
  v_add_u32 v20, s33, v20
  v_xor_b32 v20, v20, v17
  v_add_u32 v2, v16, v20
  v_add_u32 v3, 0x10000, v2
  s_add_u32 m0, s50, 16384
  s_nop 0
  buffer_load_dwordx4 v80, s[4:7], s38 offen lds
  buffer_load_dwordx4 v81, s[4:7], s38 offen offset:1024 lds
  s_add_u32 s38, s38, 128
  s_add_u32 m0, s50, 81920
  s_nop 0
  buffer_load_dwordx4 v4, s[8:11], s39 offen lds
  buffer_load_dwordx4 v4, s[8:11], s40 offen offset:1024 lds
  s_add_u32 s39, s39, 221184
  s_add_u32 s40, s40, 221184
  s_lshl_b32 s33, s29, 7
  s_lshl_b32 s34, s31, 5
  s_add_u32 s47, s33, s34
  s_mul_i32 s66, s28, 61440
  s_lshl_b32 s33, s30, 8
  s_add_u32 s66, s66, s33
  s_add_u32 s67, s66, 29696
  v_lshrrev_b32 v16, 5, v1
  v_lshlrev_b32 v16, 4, v16
  s_lshl_b32 s33, s32, 7
  s_add_u32 s33, s33, 131072
  v_add_u32 v8, s33, v16
  s_mov_b32 s54, 0xc0135761
  v_mov_b32 v9, 0xbdd2d3e8
  s_lshl_b32 s33, s30, 1
  s_add_u32 s33, s33, s32
  s_cmp_le_u32 s33, 26
  s_cselect_b32 s48, 0, 0x80000000
  s_cmp_le_u32 s33, 25
  s_cselect_b32 s57, 0, 0x80000000
  s_cmp_eq_u32 s33, 27
  s_cselect_b32 s57, 0, s57
  s_lshl_b32 s33, s36, 1
  s_add_u32 s33, s33, s32
  s_lshl_b32 s33, s33, 10
  s_lshr_b32 s34, s47, 4
  s_mul_i32 s34, s34, 27648
  s_add_u32 s33, s33, s34
  s_or_b32 s33, s33, s48
  v_bfe_u32 v16, v1, 4, 1
  v_mul_u32_u24 v16, 27648, v16
  v_lshrrev_b32 v17, 5, v1
  v_lshlrev_b32 v17, 8, v17
  v_add_u32 v16, v16, v17
  v_and_b32 v17, 15, v1
  v_lshlrev_b32 v17, 4, v17
  v_add_u32 v16, v16, v17
  v_add_u32 v10, s33, v16
  s_add_u32 m0, s50, 32768
  s_nop 0
  buffer_load_dwordx4 v80, s[4:7], s38 offen lds
  buffer_load_dwordx4 v81, s[4:7], s38 offen offset:1024 lds
  s_add_u32 s38, s38, 128
  s_add_u32 m0, s50, 98304
  s_nop 0
  buffer_load_dwordx4 v4, s[8:11], s39 offen lds
  buffer_load_dwordx4 v4, s[8:11], s40 offen offset:1024 lds
  s_add_u32 s39, s39, 221184
  s_add_u32 s40, s40, 221184
  s_lshr_b32 s33, s28, 1
  s_lshl_b32 s34, s30, 1
  s_add_u32 s34, s34, s33
  s_sub_u32 s34, s34, 2
  s_cmp_eq_u32 s33, 0
  s_cselect_b32 s34, s36, s34
  s_cmp_eq_u32 s33, 1
  s_cselect_b32 s34, s37, s34
  s_lshl_b32 s34, s34, 7
  s_and_b32 s52, s28, 1
  s_lshl_b32 s52, s52, 6
  s_add_u32 s34, s34, s52
  s_mov_b32 s52, 3840
  s_cmp_lt_u32 s33, 2
  s_cselect_b32 s42, 3456, s52
  s_mul_i32 s52, s29, 40
  s_mul_i32 s52, s52, s42
  s_add_u32 s43, s34, s52
  v_lshrrev_b32 v235, 3, v1
  v_mul_lo_u32 v235, v235, s42
  v_and_b32 v20, 7, v1
  v_lshlrev_b32 v20, 3, v20
  v_add_u32 v235, v235, v20
  buffer_load_dword v212, v234, s[4:7], s41 offen offset:0
  buffer_load_dword v213, v234, s[4:7], s41 offen offset:256
  buffer_load_dword v214, v234, s[4:7], s41 offen offset:512
  buffer_load_dword v215, v234, s[4:7], s41 offen offset:768
  buffer_load_dword v216, v234, s[4:7], s41 offen offset:1024
  s_cmp_lt_u32 s28, 4
  s_cselect_b32 s24, s8, s12
  s_cselect_b32 s25, s9, s13
  s_cselect_b32 s26, s10, s14
  s_mov_b32 s27, 0x00020000
  s_lshl_b32 s42, s42, 3
  buffer_load_dwordx2 v[224:225], v235, s[24:27], s43 offen
  s_add_u32 s43, s43, s42
  buffer_load_dwordx2 v[226:227], v235, s[24:27], s43 offen
  s_add_u32 s43, s43, s42
  buffer_load_dwordx2 v[228:229], v235, s[24:27], s43 offen
  s_add_u32 s43, s43, s42
  buffer_load_dwordx2 v[230:231], v235, s[24:27], s43 offen
  s_add_u32 s43, s43, s42
  buffer_load_dwordx2 v[232:233], v235, s[24:27], s43 offen
  s_lshl_b32 s43, s30, 3
  s_add_u32 s43, s43, s28
  s_lshl_b32 s43, s43, 12
  s_add_u32 s43, s43, 14680064
  s_lshl_b32 s45, s37, 1
  s_add_u32 s45, s45, s32
  s_sub_u32 s45, s45, 27
  s_max_i32 s45, s45, 0
  s_lshr_b32 s34, s47, 5
  s_mul_i32 s56, s34, 55296
  s_lshl_b32 s33, s45, 11
  s_add_u32 s56, s56, s33
  s_add_u32 s56, s56, 0
  s_lshl_b32 s33, s29, 2
  s_add_u32 s33, s33, s31
  s_mul_i32 s33, s33, 7168
  s_add_u32 s68, s33, 15269888
  s_add_u32 s69, s68, 4096
  s_cmp_lt_u32 s30, 14
  s_cselect_b32 s33, 0, 0x80000000
  s_cmp_eq_u32 s32, 0
  s_cselect_b32 s33, s33, 0x80000000
  s_min_u32 s34, s30, 13
  s_lshl_b32 s34, s34, 9
  s_or_b32 s33, s33, s34
  v_lshlrev_b32 v16, 4, v1
  v_lshrrev_b32 v17, 5, v1
  v_lshlrev_b32 v17, 31, v17
  v_or_b32 v16, v16, v17
  v_or_b32 v14, s33, v16
  s_cmp_eq_u32 s57, 0
  s_cselect_b32 s70, -1, 0
  s_lshl_b32 s33, s28, 8
  s_add_u32 s33, s33, 149504
  v_and_b32 v16, 31, v1
  v_lshlrev_b32 v16, 3, v16
  v_add_u32 v18, s33, v16
  v_and_b32 v16, 31, v1
  v_bfe_u32 v17, v1, 1, 2
  v_lshlrev_b32 v17, 4, v17
  v_lshlrev_b32 v16, 6, v16
  v_add_u32 v16, v16, v17
  v_lshrrev_b32 v17, 5, v1
  v_lshlrev_b32 v17, 3, v17
  v_add_u32 v16, v16, v17
  s_lshl_b32 s33, s28, 11
  s_add_u32 s33, s33, 132096
  v_add_u32 v12, s33, v16
  v_lshrrev_b32 v16, 4, v1
  v_lshlrev_b32 v16, 3, v16
  v_bfe_u32 v17, v1, 2, 2
  v_add_u32 v16, v16, v17
  v_lshlrev_b32 v16, 6, v16
  v_lshrrev_b32 v17, 1, v17
  v_bfe_u32 v20, v1, 1, 1
  v_xor_b32 v17, v17, v20
  v_lshlrev_b32 v17, 4, v17
  v_add_u32 v16, v16, v17
  v_and_b32 v17, 1, v1
  v_lshlrev_b32 v17, 3, v17
  v_add_u32 v16, v16, v17
  v_add_u32 v13, s33, v16
  v_lshrrev_b32 v16, 5, v1
  s_lshl_b32 s33, s32, 3
  v_add_u32 v16, s33, v16
  v_lshlrev_b32 v16, 14, v16
  v_and_b32 v17, 31, v1
  v_add_u32 v17, s47, v17
  v_lshlrev_b32 v17, 3, v17
  v_add_u32 v11, v16, v17
  s_lshl_b32 s55, s30, 19
  s_add_u32 s55, s55, 16777216
  s_mov_b32 s58, 3670016
  s_mov_b32 s46, 13697024
  buffer_load_dwordx2 v[206:207], v240, s[20:23], 0 offen sc1
  s_and_b32 s33, s2, 6
  s_lshl_b32 s33, s33, 2
  s_bfe_u32 s34, s2, 0x30003
  s_add_u32 s33, s33, s34
  s_lshl_b32 s33, s33, 3
  s_and_b32 s34, s2, 1
  s_lshl_b32 s34, s34, 2
  s_add_u32 s33, s33, s34
  s_lshr_b32 s34, s2, 6
  s_add_u32 s33, s33, s34
  s_lshl_b32 s33, s33, 3
  s_add_u32 s33, s33, s28
  s_lshl_b32 s33, s33, 12
  s_add_u32 s64, s64, s33
  s_addc_u32 s65, s65, 0
  s_waitcnt vmcnt(19)
  s_waitcnt lgkmcnt(0)
  s_barrier
  ds_read_b128 v[92:95], v76 offset:0
  ds_read_b64_tr_b16 v[28:29], v3 offset:0
  ds_read_b64_tr_b16 v[30:31], v3 offset:512
  ds_read_b64_tr_b16 v[32:33], v3 offset:8192
  ds_read_b64_tr_b16 v[34:35], v3 offset:8704
  ds_read_b128 v[96:99], v77 offset:0
  ds_read_b64_tr_b16 v[36:37], v3 offset:2048
  ds_read_b64_tr_b16 v[38:39], v3 offset:2560
  ds_read_b64_tr_b16 v[40:41], v3 offset:10240
  ds_read_b64_tr_b16 v[42:43], v3 offset:10752
  s_waitcnt lgkmcnt(7)
  v_mfma_f32_32x32x16_bf16 v[44:59], v[28:31], v[92:95], 0
  s_add_u32 m0, s50, 49152
  s_nop 0
  buffer_load_dwordx4 v80, s[4:7], s38 offen lds
  buffer_load_dwordx4 v81, s[4:7], s38 offen offset:1024 lds
  s_add_u32 s38, s38, 128
  s_add_u32 m0, s50, 114688
  s_waitcnt lgkmcnt(5)
  v_mfma_f32_32x32x16_bf16 v[60:75], v[32:35], v[92:95], 0
  buffer_load_dwordx4 v4, s[8:11], s39 offen lds
  buffer_load_dwordx4 v4, s[8:11], s40 offen offset:1024 lds
  s_add_u32 s39, s39, 221184
  s_add_u32 s40, s40, 221184
  buffer_load_dwordx2 v[208:209], v240, s[20:23], 0 offen sc1
  ds_read_b128 v[100:103], v78 offset:0
  ds_read_b64_tr_b16 v[28:29], v3 offset:4096
  ds_read_b64_tr_b16 v[30:31], v3 offset:4608
  ds_read_b64_tr_b16 v[32:33], v3 offset:12288
  ds_read_b64_tr_b16 v[34:35], v3 offset:12800
  s_waitcnt lgkmcnt(7)
  v_mfma_f32_32x32x16_bf16 v[44:59], v[36:39], v[96:99], v[44:59]
  s_waitcnt lgkmcnt(5)
  v_mfma_f32_32x32x16_bf16 v[60:75], v[40:43], v[96:99], v[60:75]
  ds_read_b128 v[104:107], v79 offset:0
  ds_read_b64_tr_b16 v[36:37], v3 offset:6144
  ds_read_b64_tr_b16 v[38:39], v3 offset:6656
  ds_read_b64_tr_b16 v[40:41], v3 offset:14336
  ds_read_b64_tr_b16 v[42:43], v3 offset:14848
  s_waitcnt lgkmcnt(7)
  v_mfma_f32_32x32x16_bf16 v[44:59], v[28:31], v[100:103], v[44:59]
  s_waitcnt lgkmcnt(5)
  v_mfma_f32_32x32x16_bf16 v[60:75], v[32:35], v[100:103], v[60:75]
  s_waitcnt vmcnt(20)
  s_waitcnt lgkmcnt(0)
  s_barrier
  ds_read_b128 v[108:111], v76 offset:16384
  ds_read_b64_tr_b16 v[28:29], v3 offset:16384
  ds_read_b64_tr_b16 v[30:31], v3 offset:16896
  ds_read_b64_tr_b16 v[32:33], v3 offset:24576
  ds_read_b64_tr_b16 v[34:35], v3 offset:25088
  v_mfma_f32_32x32x16_bf16 v[44:59], v[36:39], v[104:107], v[44:59]
  s_add_u32 m0, s50, 0
  s_nop 0
  buffer_load_dwordx4 v80, s[4:7], s38 offen lds
  buffer_load_dwordx4 v81, s[4:7], s38 offen offset:1024 lds
  s_add_u32 s38, s38, 128
  s_add_u32 m0, s50, 65536
  v_mfma_f32_32x32x16_bf16 v[60:75], v[40:43], v[104:107], v[60:75]
  buffer_load_dwordx4 v4, s[8:11], s39 offen lds
  buffer_load_dwordx4 v4, s[8:11], s40 offen offset:1024 lds
  s_add_u32 s39, s39, 221184
  s_add_u32 s40, s40, 221184
  ds_read_b128 v[112:115], v77 offset:16384
  ds_read_b64_tr_b16 v[36:37], v3 offset:18432
  ds_read_b64_tr_b16 v[38:39], v3 offset:18944
  ds_read_b64_tr_b16 v[40:41], v3 offset:26624
  ds_read_b64_tr_b16 v[42:43], v3 offset:27136
  s_waitcnt lgkmcnt(7)
  v_mfma_f32_32x32x16_bf16 v[44:59], v[28:31], v[108:111], v[44:59]
  s_waitcnt lgkmcnt(5)
  v_mfma_f32_32x32x16_bf16 v[60:75], v[32:35], v[108:111], v[60:75]
  ds_read_b128 v[116:119], v78 offset:16384
  ds_read_b64_tr_b16 v[28:29], v3 offset:20480
  ds_read_b64_tr_b16 v[30:31], v3 offset:20992
  ds_read_b64_tr_b16 v[32:33], v3 offset:28672
  ds_read_b64_tr_b16 v[34:35], v3 offset:29184
  s_waitcnt vmcnt(19)
  v_and_b32 v217, 0xffff0000, v212
  s_waitcnt vmcnt(14)
  v_lshlrev_b32 v236, 16, v224
  v_lshlrev_b32 v212, 16, v212
  v_and_b32 v237, 0xffff0000, v224
  v_and_b32 v218, 0xffff0000, v213
  v_lshlrev_b32 v238, 16, v225
  v_lshlrev_b32 v213, 16, v213
  v_and_b32 v239, 0xffff0000, v225
  v_and_b32 v219, 0xffff0000, v214
  s_waitcnt vmcnt(13)
  v_lshlrev_b32 v20, 16, v226
  s_waitcnt lgkmcnt(7)
  v_mfma_f32_32x32x16_bf16 v[44:59], v[36:39], v[112:115], v[44:59]
  s_waitcnt lgkmcnt(5)
  v_mfma_f32_32x32x16_bf16 v[60:75], v[40:43], v[112:115], v[60:75]
  ds_read_b128 v[120:123], v79 offset:16384
  ds_read_b64_tr_b16 v[36:37], v3 offset:22528
  ds_read_b64_tr_b16 v[38:39], v3 offset:23040
  ds_read_b64_tr_b16 v[40:41], v3 offset:30720
  ds_read_b64_tr_b16 v[42:43], v3 offset:31232
  v_lshlrev_b32 v214, 16, v214
  v_and_b32 v21, 0xffff0000, v226
  v_and_b32 v220, 0xffff0000, v215
  v_lshlrev_b32 v22, 16, v227
  v_lshlrev_b32 v215, 16, v215
  v_and_b32 v23, 0xffff0000, v227
  v_and_b32 v221, 0xffff0000, v216
  v_add_f32 v236, v236, v20
  v_lshlrev_b32 v216, 16, v216
  v_add_f32 v237, v237, v21
  s_waitcnt lgkmcnt(7)
  v_mfma_f32_32x32x16_bf16 v[44:59], v[28:31], v[116:119], v[44:59]
  s_waitcnt lgkmcnt(5)
  v_mfma_f32_32x32x16_bf16 v[60:75], v[32:35], v[116:119], v[60:75]
  s_waitcnt vmcnt(9)
  v_or_b32 v204, v204, v206
  v_or_b32 v205, v205, v207
  s_waitcnt vmcnt(4)
  v_or_b32 v204, v204, v208
  v_or_b32 v205, v205, v209
  v_readfirstlane_b32 s60, v204
  v_readfirstlane_b32 s61, v205
  s_cmp_lg_u32 s28, 0
  s_cbranch_scc1 P1_nonw
  s_nop 0
  s_cmp_eq_u32 s60, 0
  s_cbranch_scc1 P1_nspin
P1_nok:
  v_mov_b32 v204, s60
  v_mov_b32 v205, s61
  v_mov_b32 v206, 132096
  ds_write_b64 v206, v[204:205]
P1_nonw:
  s_waitcnt lgkmcnt(0)
  s_barrier
  ds_read_b128 v[124:127], v76 offset:32768
  ds_read_b64_tr_b16 v[28:29], v3 offset:32768
  ds_read_b64_tr_b16 v[30:31], v3 offset:33280
  ds_read_b64_tr_b16 v[32:33], v3 offset:40960
  ds_read_b64_tr_b16 v[34:35], v3 offset:41472
  v_add_f32 v222, v212, v213
  v_add_f32 v238, v238, v22
  v_add_f32 v223, v214, v215
  v_add_f32 v239, v239, v23
  v_add_f32 v222, v222, v216
  v_lshlrev_b32 v20, 16, v228
  v_add_f32 v223, v223, v217
  v_and_b32 v21, 0xffff0000, v228
  v_add_f32 v222, v222, v218
  v_lshlrev_b32 v22, 16, v229
  v_mfma_f32_32x32x16_bf16 v[44:59], v[36:39], v[120:123], v[44:59]
  s_add_u32 m0, s50, 16384
  s_nop 0
  buffer_load_dwordx4 v80, s[4:7], s38 offen lds
  buffer_load_dwordx4 v81, s[4:7], s38 offen offset:1024 lds
  s_add_u32 s38, s38, 128
  s_add_u32 m0, s50, 81920
  v_mfma_f32_32x32x16_bf16 v[60:75], v[40:43], v[120:123], v[60:75]
  buffer_load_dwordx4 v4, s[8:11], s39 offen lds
  buffer_load_dwordx4 v4, s[8:11], s40 offen offset:1024 lds
  s_add_u32 s39, s39, 221184
  s_add_u32 s40, s40, 221184
  ds_read_b128 v[128:131], v77 offset:32768
  ds_read_b64_tr_b16 v[36:37], v3 offset:34816
  ds_read_b64_tr_b16 v[38:39], v3 offset:35328
  ds_read_b64_tr_b16 v[40:41], v3 offset:43008
  ds_read_b64_tr_b16 v[42:43], v3 offset:43520
  v_add_f32 v223, v223, v219
  v_and_b32 v23, 0xffff0000, v229
  v_add_f32 v222, v222, v220
  v_add_f32 v236, v236, v20
  v_add_f32 v223, v223, v221
  v_add_f32 v237, v237, v21
  v_add_f32 v222, v222, v223
  v_add_f32 v238, v238, v22
  s_nop 0
  v_add_f32_dpp v222, v222, v222 quad_perm:[1,0,3,2] row_mask:0xf bank_mask:0xf
  v_add_f32 v239, v239, v23
  s_waitcnt lgkmcnt(7)
  v_mfma_f32_32x32x16_bf16 v[44:59], v[28:31], v[124:127], v[44:59]
  s_waitcnt lgkmcnt(5)
  v_mfma_f32_32x32x16_bf16 v[60:75], v[32:35], v[124:127], v[60:75]
  ds_read_b128 v[132:135], v78 offset:32768
  ds_read_b64_tr_b16 v[28:29], v3 offset:36864
  ds_read_b64_tr_b16 v[30:31], v3 offset:37376
  ds_read_b64_tr_b16 v[32:33], v3 offset:45056
  ds_read_b64_tr_b16 v[34:35], v3 offset:45568
  v_add_f32_dpp v222, v222, v222 quad_perm:[2,3,0,1] row_mask:0xf bank_mask:0xf
  v_lshlrev_b32 v20, 16, v230
  s_nop 0
  v_add_f32_dpp v222, v222, v222 row_half_mirror row_mask:0xf bank_mask:0xf
  v_and_b32 v21, 0xffff0000, v230
  s_nop 0
  v_add_f32_dpp v222, v222, v222 row_mirror row_mask:0xf bank_mask:0xf
  v_lshlrev_b32 v22, 16, v231
  v_mov_b32 v223, v222
  v_and_b32 v23, 0xffff0000, v231
  s_nop 0
  v_permlane16_swap_b32 v222, v223
  v_add_f32 v236, v236, v20
  s_waitcnt lgkmcnt(7)
  v_mfma_f32_32x32x16_bf16 v[44:59], v[36:39], v[128:131], v[44:59]
  s_waitcnt lgkmcnt(5)
  v_mfma_f32_32x32x16_bf16 v[60:75], v[40:43], v[128:131], v[60:75]
  ds_read_b128 v[136:139], v79 offset:32768
  ds_read_b64_tr_b16 v[36:37], v3 offset:38912
  ds_read_b64_tr_b16 v[38:39], v3 offset:39424
  ds_read_b64_tr_b16 v[40:41], v3 offset:47104
  ds_read_b64_tr_b16 v[42:43], v3 offset:47616
  v_add_f32 v222, v222, v223
  v_add_f32 v237, v237, v21
  v_mov_b32 v223, v222
  v_add_f32 v238, v238, v22
  s_nop 0
  v_permlane32_swap_b32 v222, v223
  v_add_f32 v239, v239, v23
  v_add_f32 v222, v222, v223
  v_lshlrev_b32 v20, 16, v232
  v_mul_f32 v222, 0x3acccccd, v222
  v_and_b32 v21, 0xffff0000, v232
  s_waitcnt lgkmcnt(7)
  v_mfma_f32_32x32x16_bf16 v[44:59], v[28:31], v[132:135], v[44:59]
  s_waitcnt lgkmcnt(5)
  v_mfma_f32_32x32x16_bf16 v[60:75], v[32:35], v[132:135], v[60:75]
  s_waitcnt lgkmcnt(0)
  s_barrier
  ds_read_b128 v[140:143], v76 offset:49152
  ds_read_b64_tr_b16 v[28:29], v3 offset:49152
  ds_read_b64_tr_b16 v[30:31], v3 offset:49664
  ds_read_b64_tr_b16 v[32:33], v3 offset:57344
  ds_read_b64_tr_b16 v[34:35], v3 offset:57856
  v_sub_f32 v212, v212, v222
  v_lshlrev_b32 v22, 16, v233
  v_sub_f32 v213, v213, v222
  v_and_b32 v23, 0xffff0000, v233
  v_sub_f32 v214, v214, v222
  v_add_f32 v236, v236, v20
  v_sub_f32 v215, v215, v222
  v_add_f32 v237, v237, v21
  v_sub_f32 v216, v216, v222
  v_add_f32 v238, v238, v22
  v_mfma_f32_32x32x16_bf16 v[44:59], v[36:39], v[136:139], v[44:59]
  s_add_u32 m0, s50, 32768
  s_nop 0
  buffer_load_dwordx4 v80, s[4:7], s38 offen lds
  buffer_load_dwordx4 v81, s[4:7], s38 offen offset:1024 lds
  s_add_u32 s38, s38, 128
  s_add_u32 m0, s50, 98304
  v_mfma_f32_32x32x16_bf16 v[60:75], v[40:43], v[136:139], v[60:75]
  buffer_load_dwordx4 v4, s[8:11], s39 offen lds
  buffer_load_dwordx4 v4, s[8:11], s40 offen offset:1024 lds
  s_add_u32 s39, s39, 221184
  s_add_u32 s40, s40, 221184
  ds_read_b128 v[144:147], v77 offset:49152
  ds_read_b64_tr_b16 v[36:37], v3 offset:51200
  ds_read_b64_tr_b16 v[38:39], v3 offset:51712
  ds_read_b64_tr_b16 v[40:41], v3 offset:59392
  ds_read_b64_tr_b16 v[42:43], v3 offset:59904
  v_sub_f32 v217, v217, v222
  v_add_f32 v239, v239, v23
  v_sub_f32 v218, v218, v222
  v_permlane32_swap_b32 v236, v238
  v_sub_f32 v219, v219, v222
  v_and_b32 v24, 7, v1
  v_sub_f32 v220, v220, v222
  v_permlane32_swap_b32 v237, v239
  v_sub_f32 v221, v221, v222
  v_lshlrev_b32 v24, 5, v24
  s_waitcnt lgkmcnt(7)
  v_mfma_f32_32x32x16_bf16 v[44:59], v[28:31], v[140:143], v[44:59]
  s_waitcnt lgkmcnt(5)
  v_mfma_f32_32x32x16_bf16 v[60:75], v[32:35], v[140:143], v[60:75]
  ds_read_b128 v[148:151], v78 offset:49152
  ds_read_b64_tr_b16 v[28:29], v3 offset:53248
  ds_read_b64_tr_b16 v[30:31], v3 offset:53760
  ds_read_b64_tr_b16 v[32:33], v3 offset:61440
  ds_read_b64_tr_b16 v[34:35], v3 offset:61952
  v_mul_f32 v241, v212, v212
  v_add_f32 v248, v236, v238
  v_mul_f32 v223, v213, v213
  v_add_f32 v249, v237, v239
  v_fmac_f32 v241, v214, v214
  v_lshrrev_b32 v25, 5, v1
  v_fmac_f32 v223, v215, v215
  v_mov_b32 v236, v248
  v_fmac_f32 v241, v216, v216
  v_mov_b32 v237, v249
  s_waitcnt lgkmcnt(7)
  v_mfma_f32_32x32x16_bf16 v[44:59], v[36:39], v[144:147], v[44:59]
  s_waitcnt lgkmcnt(5)
  v_mfma_f32_32x32x16_bf16 v[60:75], v[40:43], v[144:147], v[60:75]
  ds_read_b128 v[152:155], v79 offset:49152
  ds_read_b64_tr_b16 v[36:37], v3 offset:55296
  ds_read_b64_tr_b16 v[38:39], v3 offset:55808
  ds_read_b64_tr_b16 v[40:41], v3 offset:63488
  ds_read_b64_tr_b16 v[42:43], v3 offset:64000
  v_fmac_f32 v223, v217, v217
  v_lshlrev_b32 v25, 4, v25
  v_fmac_f32 v241, v218, v218
  v_add_u32 v24, v24, v25
  v_fmac_f32 v223, v219, v219
  v_permlane16_swap_b32 v248, v236
  v_fmac_f32 v241, v220, v220
  v_permlane16_swap_b32 v249, v237
  v_fmac_f32 v223, v221, v221
  v_and_b32 v25, 0x18, v1
  s_waitcnt lgkmcnt(7)
  v_mfma_f32_32x32x16_bf16 v[44:59], v[28:31], v[148:151], v[44:59]
  s_waitcnt lgkmcnt(5)
  v_mfma_f32_32x32x16_bf16 v[60:75], v[32:35], v[148:151], v[60:75]
  s_waitcnt vmcnt(8)
  s_waitcnt lgkmcnt(0)
  s_barrier
  ds_read_b128 v[156:159], v76 offset:0
  ds_read_b64_tr_b16 v[28:29], v3 offset:0
  ds_read_b64_tr_b16 v[30:31], v3 offset:512
  ds_read_b64_tr_b16 v[32:33], v3 offset:8192
  ds_read_b64_tr_b16 v[34:35], v3 offset:8704
  v_add_f32 v241, v241, v223
  v_add_f32 v248, v248, v236
  s_nop 0
  v_add_f32_dpp v241, v241, v241 quad_perm:[1,0,3,2] row_mask:0xf bank_mask:0xf
  v_add_f32 v249, v249, v237
  s_nop 0
  v_add_f32_dpp v241, v241, v241 quad_perm:[2,3,0,1] row_mask:0xf bank_mask:0xf
  v_min_u32 v25, 1, v25
  s_nop 0
  v_add_f32_dpp v241, v241, v241 row_half_mirror row_mask:0xf bank_mask:0xf
  v_lshlrev_b32 v25, 31, v25
  s_nop 0
  v_add_f32_dpp v241, v241, v241 row_mirror row_mask:0xf bank_mask:0xf
  v_add_f32_dpp v248, v248, v248 row_ror:8 row_mask:0xf bank_mask:0xf
  v_mfma_f32_32x32x16_bf16 v[44:59], v[36:39], v[152:155], v[44:59]
  s_add_u32 m0, s50, 49152
  s_nop 0
  buffer_load_dwordx4 v80, s[4:7], s38 offen lds
  buffer_load_dwordx4 v81, s[4:7], s38 offen offset:1024 lds
  s_add_u32 s38, s38, 128
  s_add_u32 m0, s50, 114688
  v_mfma_f32_32x32x16_bf16 v[60:75], v[40:43], v[152:155], v[60:75]
  buffer_load_dwordx4 v4, s[8:11], s39 offen lds
  buffer_load_dwordx4 v4, s[8:11], s40 offen offset:1024 lds
  s_add_u32 s39, s39, 221184
  s_add_u32 s40, s40, 221184
  ds_read_b128 v[160:163], v77 offset:0
  ds_read_b64_tr_b16 v[36:37], v3 offset:2048
  ds_read_b64_tr_b16 v[38:39], v3 offset:2560
  ds_read_b64_tr_b16 v[40:41], v3 offset:10240
  ds_read_b64_tr_b16 v[42:43], v3 offset:10752
  v_mov_b32 v223, v241
  v_add_f32_dpp v249, v249, v249 row_ror:8 row_mask:0xf bank_mask:0xf
  s_nop 0
  v_permlane16_swap_b32 v241, v223
  v_or_b32 v24, v24, v25
  v_add_f32 v241, v241, v223
  v_mov_b32 v223, v241
  s_nop 1
  v_permlane32_swap_b32 v241, v223
  v_add_f32 v241, v241, v223
  v_mov_b32 v223, 0x3727c5ac
  v_fmac_f32 v223, 0x3acccccd, v241
  s_waitcnt lgkmcnt(7)
  v_mfma_f32_32x32x16_bf16 v[44:59], v[28:31], v[156:159], v[44:59]
  s_waitcnt lgkmcnt(5)
  v_mfma_f32_32x32x16_bf16 v[60:75], v[32:35], v[156:159], v[60:75]
  ds_read_b128 v[164:167], v78 offset:0
  ds_read_b64_tr_b16 v[28:29], v3 offset:4096
  ds_read_b64_tr_b16 v[30:31], v3 offset:4608
  ds_read_b64_tr_b16 v[32:33], v3 offset:12288
  ds_read_b64_tr_b16 v[34:35], v3 offset:12800
  v_rsq_f32 v244, v223
  v_sub_f32 v245, 0, v222
  v_mov_b32 v26, 132096
  ds_read_b64 v[246:247], v26
  s_lshl_b32 s33, s29, 8
  s_add_u32 s33, s33, s43
  s_waitcnt lgkmcnt(0)
  v_mov_b32 v250, v246
  v_mov_b32 v251, v247
  buffer_store_dwordx4 v[244:247], v15, s[16:19], s44 offen sc1
  buffer_store_dwordx4 v[248:251], v24, s[16:19], s33 offen sc1
  v_mfma_f32_32x32x16_bf16 v[44:59], v[36:39], v[160:163], v[44:59]
  v_mfma_f32_32x32x16_bf16 v[60:75], v[40:43], v[160:163], v[60:75]
  ds_read_b128 v[168:171], v79 offset:0
  ds_read_b64_tr_b16 v[36:37], v3 offset:6144
  ds_read_b64_tr_b16 v[38:39], v3 offset:6656
  ds_read_b64_tr_b16 v[40:41], v3 offset:14336
  ds_read_b64_tr_b16 v[42:43], v3 offset:14848
  v_readfirstlane_b32 s60, v246
  v_readfirstlane_b32 s61, v247
  v_mfma_f32_32x32x16_bf16 v[44:59], v[28:31], v[164:167], v[44:59]
  v_mfma_f32_32x32x16_bf16 v[60:75], v[32:35], v[164:167], v[60:75]
  s_waitcnt vmcnt(10)
  s_waitcnt lgkmcnt(0)
  s_barrier
  ds_read_b128 v[172:175], v76 offset:16384
  ds_read_b64_tr_b16 v[28:29], v3 offset:16384
  ds_read_b64_tr_b16 v[30:31], v3 offset:16896
  ds_read_b64_tr_b16 v[32:33], v3 offset:24576
  ds_read_b64_tr_b16 v[34:35], v3 offset:25088
  v_mfma_f32_32x32x16_bf16 v[44:59], v[36:39], v[168:171], v[44:59]
  s_add_u32 m0, s50, 0
  s_nop 0
  buffer_load_dwordx4 v80, s[4:7], s38 offen lds
  buffer_load_dwordx4 v81, s[4:7], s38 offen offset:1024 lds
  s_add_u32 s38, s38, 128
  s_add_u32 m0, s50, 65536
  v_mfma_f32_32x32x16_bf16 v[60:75], v[40:43], v[168:171], v[60:75]
  buffer_load_dwordx4 v4, s[8:11], s39 offen lds
  buffer_load_dwordx4 v4, s[8:11], s40 offen offset:1024 lds
  s_add_u32 s39, s39, 221184
  s_add_u32 s40, s40, 221184
  ds_read_b128 v[176:179], v77 offset:16384
  ds_read_b64_tr_b16 v[36:37], v3 offset:18432
  ds_read_b64_tr_b16 v[38:39], v3 offset:18944
  ds_read_b64_tr_b16 v[40:41], v3 offset:26624
  ds_read_b64_tr_b16 v[42:43], v3 offset:27136
  s_waitcnt lgkmcnt(7)
  v_mfma_f32_32x32x16_bf16 v[44:59], v[28:31], v[172:175], v[44:59]
  s_waitcnt lgkmcnt(5)
  v_mfma_f32_32x32x16_bf16 v[60:75], v[32:35], v[172:175], v[60:75]
  ds_read_b128 v[180:183], v78 offset:16384
  ds_read_b64_tr_b16 v[28:29], v3 offset:20480
  ds_read_b64_tr_b16 v[30:31], v3 offset:20992
  ds_read_b64_tr_b16 v[32:33], v3 offset:28672
  ds_read_b64_tr_b16 v[34:35], v3 offset:29184
  s_waitcnt lgkmcnt(7)
  v_mfma_f32_32x32x16_bf16 v[44:59], v[36:39], v[176:179], v[44:59]
  s_waitcnt lgkmcnt(5)
  v_mfma_f32_32x32x16_bf16 v[60:75], v[40:43], v[176:179], v[60:75]
  ds_read_b128 v[184:187], v79 offset:16384
  ds_read_b64_tr_b16 v[36:37], v3 offset:22528
  ds_read_b64_tr_b16 v[38:39], v3 offset:23040
  ds_read_b64_tr_b16 v[40:41], v3 offset:30720
  ds_read_b64_tr_b16 v[42:43], v3 offset:31232
  s_waitcnt lgkmcnt(7)
  v_mfma_f32_32x32x16_bf16 v[44:59], v[28:31], v[180:183], v[44:59]
  s_waitcnt lgkmcnt(5)
  v_mfma_f32_32x32x16_bf16 v[60:75], v[32:35], v[180:183], v[60:75]
  s_waitcnt vmcnt(10)
  s_waitcnt lgkmcnt(0)
  s_barrier
  ds_read_b128 v[188:191], v76 offset:32768
  ds_read_b64_tr_b16 v[28:29], v3 offset:32768
  ds_read_b64_tr_b16 v[30:31], v3 offset:33280
  ds_read_b64_tr_b16 v[32:33], v3 offset:40960
  ds_read_b64_tr_b16 v[34:35], v3 offset:41472
  v_mfma_f32_32x32x16_bf16 v[44:59], v[36:39], v[184:187], v[44:59]
  s_add_u32 m0, s50, 16384
  s_nop 0
  buffer_load_dwordx4 v80, s[4:7], s38 offen lds
  buffer_load_dwordx4 v81, s[4:7], s38 offen offset:1024 lds
  s_add_u32 s38, s38, 128
  s_add_u32 m0, s50, 81920
  v_mfma_f32_32x32x16_bf16 v[60:75], v[40:43], v[184:187], v[60:75]
  buffer_load_dwordx4 v4, s[8:11], s39 offen lds
  buffer_load_dwordx4 v4, s[8:11], s40 offen offset:1024 lds
  s_add_u32 s39, s39, 221184
  s_add_u32 s40, s40, 221184
  ds_read_b128 v[192:195], v77 offset:32768
  ds_read_b64_tr_b16 v[36:37], v3 offset:34816
  ds_read_b64_tr_b16 v[38:39], v3 offset:35328
  ds_read_b64_tr_b16 v[40:41], v3 offset:43008
  ds_read_b64_tr_b16 v[42:43], v3 offset:43520
  s_waitcnt lgkmcnt(7)
  v_mfma_f32_32x32x16_bf16 v[44:59], v[28:31], v[188:191], v[44:59]
  s_waitcnt lgkmcnt(5)
  v_mfma_f32_32x32x16_bf16 v[60:75], v[32:35], v[188:191], v[60:75]
  ds_read_b128 v[196:199], v78 offset:32768
  ds_read_b64_tr_b16 v[28:29], v3 offset:36864
  ds_read_b64_tr_b16 v[30:31], v3 offset:37376
  ds_read_b64_tr_b16 v[32:33], v3 offset:45056
  ds_read_b64_tr_b16 v[34:35], v3 offset:45568
  s_waitcnt lgkmcnt(7)
  v_mfma_f32_32x32x16_bf16 v[44:59], v[36:39], v[192:195], v[44:59]
  s_waitcnt lgkmcnt(5)
  v_mfma_f32_32x32x16_bf16 v[60:75], v[40:43], v[192:195], v[60:75]
  ds_read_b128 v[200:203], v79 offset:32768
  ds_read_b64_tr_b16 v[36:37], v3 offset:38912
  ds_read_b64_tr_b16 v[38:39], v3 offset:39424
  ds_read_b64_tr_b16 v[40:41], v3 offset:47104
  ds_read_b64_tr_b16 v[42:43], v3 offset:47616
  v_and_b32 v16, 31, v1
  v_lshlrev_b32 v16, 4, v16
  v_lshlrev_b32 v17, 4, v1
  s_lshl_b32 s44, s47, 4
  s_add_u32 s44, s44, 15204352
  buffer_load_dwordx4 v[80:83], v16, s[16:19], s44 offen sc1
  buffer_load_dwordx4 v[20:23], v17, s[16:19], s43 offen offset:0 sc1
  buffer_load_dwordx4 v[24:27], v17, s[16:19], s43 offen offset:1024 sc1
  buffer_load_dwordx4 v[84:87], v17, s[16:19], s43 offen offset:2048 sc1
  buffer_load_dwordx4 v[88:91], v17, s[16:19], s43 offen offset:3072 sc1
  s_waitcnt lgkmcnt(7)
  v_mfma_f32_32x32x16_bf16 v[44:59], v[28:31], v[196:199], v[44:59]
  s_waitcnt lgkmcnt(5)
  v_mfma_f32_32x32x16_bf16 v[60:75], v[32:35], v[196:199], v[60:75]
  s_waitcnt vmcnt(15)
  s_waitcnt lgkmcnt(0)
  s_barrier
  ds_read_b128 v[204:207], v76 offset:49152
  ds_read_b64_tr_b16 v[28:29], v3 offset:49152
  ds_read_b64_tr_b16 v[30:31], v3 offset:49664
  ds_read_b64_tr_b16 v[32:33], v3 offset:57344
  ds_read_b64_tr_b16 v[34:35], v3 offset:57856
  v_mfma_f32_32x32x16_bf16 v[44:59], v[36:39], v[200:203], v[44:59]
  s_add_u32 m0, s50, 32768
  s_nop 0
  buffer_load_dwordx4 v5, s[12:15], s66 offen lds
  buffer_load_dwordx4 v5, s[12:15], s67 offen offset:1024 lds
  s_add_u32 s66, s66, 0x78000
  s_add_u32 s67, s67, 0x78000
  v_mfma_f32_32x32x16_bf16 v[60:75], v[40:43], v[200:203], v[60:75]
  s_add_u32 m0, s50, 98304
  s_nop 0
  buffer_load_dwordx4 v5, s[12:15], s66 offen lds
  buffer_load_dwordx4 v5, s[12:15], s67 offen offset:1024 lds
  s_add_u32 s66, s66, 0x78000
  s_add_u32 s67, s67, 0x78000
  ds_read_b128 v[208:211], v77 offset:49152
  ds_read_b64_tr_b16 v[36:37], v3 offset:51200
  ds_read_b64_tr_b16 v[38:39], v3 offset:51712
  ds_read_b64_tr_b16 v[40:41], v3 offset:59392
  ds_read_b64_tr_b16 v[42:43], v3 offset:59904
  s_waitcnt lgkmcnt(7)
  v_mfma_f32_32x32x16_bf16 v[44:59], v[28:31], v[204:207], v[44:59]
  s_waitcnt lgkmcnt(5)
  v_mfma_f32_32x32x16_bf16 v[60:75], v[32:35], v[204:207], v[60:75]
  ds_read_b128 v[212:215], v78 offset:49152
  ds_read_b64_tr_b16 v[28:29], v3 offset:53248
  ds_read_b64_tr_b16 v[30:31], v3 offset:53760
  ds_read_b64_tr_b16 v[32:33], v3 offset:61440
  ds_read_b64_tr_b16 v[34:35], v3 offset:61952
  s_waitcnt lgkmcnt(7)
  v_mfma_f32_32x32x16_bf16 v[44:59], v[36:39], v[208:211], v[44:59]
  s_waitcnt lgkmcnt(5)
  v_mfma_f32_32x32x16_bf16 v[60:75], v[40:43], v[208:211], v[60:75]
  ds_read_b128 v[216:219], v79 offset:49152
  ds_read_b64_tr_b16 v[36:37], v3 offset:55296
  ds_read_b64_tr_b16 v[38:39], v3 offset:55808
  ds_read_b64_tr_b16 v[40:41], v3 offset:63488
  ds_read_b64_tr_b16 v[42:43], v3 offset:64000
  s_waitcnt lgkmcnt(7)
  v_mfma_f32_32x32x16_bf16 v[44:59], v[28:31], v[212:215], v[44:59]
  s_waitcnt lgkmcnt(5)
  v_mfma_f32_32x32x16_bf16 v[60:75], v[32:35], v[212:215], v[60:75]
  s_waitcnt vmcnt(13)
  s_waitcnt lgkmcnt(0)
  s_barrier
  ds_read_b128 v[220:223], v76 offset:0
  ds_read_b64_tr_b16 v[28:29], v3 offset:0
  ds_read_b64_tr_b16 v[30:31], v3 offset:512
  ds_read_b64_tr_b16 v[32:33], v3 offset:8192
  ds_read_b64_tr_b16 v[34:35], v3 offset:8704
  v_mfma_f32_32x32x16_bf16 v[44:59], v[36:39], v[216:219], v[44:59]
  s_add_u32 m0, s50, 49152
  s_nop 0
  buffer_load_dwordx4 v5, s[12:15], s66 offen lds
  buffer_load_dwordx4 v5, s[12:15], s67 offen offset:1024 lds
  s_add_u32 s66, s66, 0x78000
  s_add_u32 s67, s67, 0x78000
  v_mfma_f32_32x32x16_bf16 v[60:75], v[40:43], v[216:219], v[60:75]
  s_add_u32 m0, s50, 114688
  s_nop 0
  buffer_load_dwordx4 v5, s[12:15], s66 offen lds
  buffer_load_dwordx4 v5, s[12:15], s67 offen offset:1024 lds
  s_add_u32 s66, s66, 0x78000
  s_add_u32 s67, s67, 0x78000
  ds_read_b128 v[224:227], v77 offset:0
  ds_read_b64_tr_b16 v[36:37], v3 offset:2048
  ds_read_b64_tr_b16 v[38:39], v3 offset:2560
  ds_read_b64_tr_b16 v[40:41], v3 offset:10240
  ds_read_b64_tr_b16 v[42:43], v3 offset:10752
  s_waitcnt lgkmcnt(7)
  v_mfma_f32_32x32x16_bf16 v[44:59], v[28:31], v[220:223], v[44:59]
  s_waitcnt lgkmcnt(5)
  v_mfma_f32_32x32x16_bf16 v[60:75], v[32:35], v[220:223], v[60:75]
  ds_read_b128 v[228:231], v78 offset:0
  ds_read_b64_tr_b16 v[28:29], v3 offset:4096
  ds_read_b64_tr_b16 v[30:31], v3 offset:4608
  ds_read_b64_tr_b16 v[32:33], v3 offset:12288
  ds_read_b64_tr_b16 v[34:35], v3 offset:12800
  s_waitcnt lgkmcnt(7)
  v_mfma_f32_32x32x16_bf16 v[44:59], v[36:39], v[224:227], v[44:59]
  s_waitcnt lgkmcnt(5)
  v_mfma_f32_32x32x16_bf16 v[60:75], v[40:43], v[224:227], v[60:75]
  ds_read_b128 v[232:235], v79 offset:0
  ds_read_b64_tr_b16 v[36:37], v3 offset:6144
  ds_read_b64_tr_b16 v[38:39], v3 offset:6656
  ds_read_b64_tr_b16 v[40:41], v3 offset:14336
  ds_read_b64_tr_b16 v[42:43], v3 offset:14848
  s_waitcnt lgkmcnt(7)
  v_mfma_f32_32x32x16_bf16 v[44:59], v[28:31], v[228:231], v[44:59]
  s_waitcnt lgkmcnt(5)
  v_mfma_f32_32x32x16_bf16 v[60:75], v[32:35], v[228:231], v[60:75]
  s_waitcnt vmcnt(13)
  s_waitcnt lgkmcnt(0)
  s_barrier
  ds_read_b128 v[236:239], v76 offset:16384
  ds_read_b64_tr_b16 v[28:29], v3 offset:16384
  ds_read_b64_tr_b16 v[30:31], v3 offset:16896
  ds_read_b64_tr_b16 v[32:33], v3 offset:24576
  ds_read_b64_tr_b16 v[34:35], v3 offset:25088
  v_mfma_f32_32x32x16_bf16 v[44:59], v[36:39], v[232:235], v[44:59]
  s_add_u32 m0, s50, 0
  s_nop 0
  buffer_load_dwordx4 v5, s[12:15], s66 offen lds
  buffer_load_dwordx4 v5, s[12:15], s67 offen offset:1024 lds
  s_add_u32 s66, s66, 0xffe20080
  s_add_u32 s67, s67, 0xffe20080
  v_mfma_f32_32x32x16_bf16 v[60:75], v[40:43], v[232:235], v[60:75]
  s_add_u32 m0, s50, 65536
  s_nop 0
  buffer_load_dwordx4 v5, s[12:15], s66 offen lds
  buffer_load_dwordx4 v5, s[12:15], s67 offen offset:1024 lds
  s_add_u32 s66, s66, 0x78000
  s_add_u32 s67, s67, 0x78000
  ds_read_b128 v[240:243], v77 offset:16384
  ds_read_b64_tr_b16 v[36:37], v3 offset:18432
  ds_read_b64_tr_b16 v[38:39], v3 offset:18944
  ds_read_b64_tr_b16 v[40:41], v3 offset:26624
  ds_read_b64_tr_b16 v[42:43], v3 offset:27136
  s_waitcnt lgkmcnt(7)
  v_mfma_f32_32x32x16_bf16 v[44:59], v[28:31], v[236:239], v[44:59]
  s_waitcnt lgkmcnt(5)
  v_mfma_f32_32x32x16_bf16 v[60:75], v[32:35], v[236:239], v[60:75]
  ds_read_b128 v[244:247], v78 offset:16384
  ds_read_b64_tr_b16 v[28:29], v3 offset:20480
  ds_read_b64_tr_b16 v[30:31], v3 offset:20992
  ds_read_b64_tr_b16 v[32:33], v3 offset:28672
  ds_read_b64_tr_b16 v[34:35], v3 offset:29184
  s_waitcnt vmcnt(16)
  v_cmp_ne_u64 vcc, s[60:61], v[82:83]
  s_nop 3
  s_mov_b64 s[52:53], vcc
  s_waitcnt vmcnt(15)
  v_cmp_ne_u64 vcc, s[60:61], v[22:23]
  s_nop 3
  s_or_b64 s[52:53], s[52:53], vcc
  s_waitcnt vmcnt(14)
  v_cmp_ne_u64 vcc, s[60:61], v[26:27]
  s_nop 3
  s_or_b64 s[52:53], s[52:53], vcc
  s_waitcnt vmcnt(13)
  v_cmp_ne_u64 vcc, s[60:61], v[86:87]
  s_nop 3
  s_or_b64 s[52:53], s[52:53], vcc
  s_waitcnt vmcnt(12)
  v_cmp_ne_u64 vcc, s[60:61], v[90:91]
  s_nop 3
  s_or_b64 s[52:53], s[52:53], vcc
  s_cmp_lg_u64 s[52:53], 0
  s_cbranch_scc1 P1_gspin
P1_gok:
  v_mov_b32 v6, v80
  v_mov_b32 v7, v81
  v_add_f32 v20, v20, v24
  v_add_f32 v21, v21, v25
  v_add_f32 v84, v84, v88
  v_add_f32 v85, v85, v89
  v_add_f32 v20, v20, v84
  v_add_f32 v21, v21, v85
  s_waitcnt lgkmcnt(7)
  v_mfma_f32_32x32x16_bf16 v[44:59], v[36:39], v[240:243], v[44:59]
  s_waitcnt lgkmcnt(5)
  v_mfma_f32_32x32x16_bf16 v[60:75], v[40:43], v[240:243], v[60:75]
  ds_read_b128 v[248:251], v79 offset:16384
  ds_read_b64_tr_b16 v[36:37], v3 offset:22528
  ds_read_b64_tr_b16 v[38:39], v3 offset:23040
  ds_read_b64_tr_b16 v[40:41], v3 offset:30720
  ds_read_b64_tr_b16 v[42:43], v3 offset:31232
  v_and_b32 v16, 15, v1
  v_lshlrev_b32 v16, 3, v16
  v_bfe_u32 v17, v1, 4, 1
  v_permlane16_swap_b32 v20, v21
  v_lshl_add_u32 v16, v17, 2, v16
  s_lshl_b32 s33, s28, 7
  s_add_u32 s33, s33, 131072
  v_add_f32 v20, v20, v21
  v_add_u32 v16, s33, v16
  v_mov_b32 v21, v20
  s_nop 1
  v_permlane32_swap_b32 v20, v21
  v_add_f32 v20, v20, v21
  ds_write_b32 v16, v20
  s_waitcnt lgkmcnt(8)
  v_mfma_f32_32x32x16_bf16 v[44:59], v[28:31], v[244:247], v[44:59]
  s_waitcnt lgkmcnt(6)
  v_mfma_f32_32x32x16_bf16 v[60:75], v[32:35], v[244:247], v[60:75]
  s_waitcnt vmcnt(10)
  s_waitcnt lgkmcnt(0)
  s_barrier
  ds_read_b64_tr_b16 v[28:29], v2 offset:32768
  ds_read_b64_tr_b16 v[30:31], v2 offset:33280
  v_mfma_f32_32x32x16_bf16 v[44:59], v[36:39], v[248:251], v[44:59]
  s_add_u32 m0, s50, 16384
  s_nop 0
  buffer_load_dwordx4 v5, s[12:15], s66 offen lds
  buffer_load_dwordx4 v5, s[12:15], s67 offen offset:1024 lds
  s_add_u32 s66, s66, 0x78000
  s_add_u32 s67, s67, 0x78000
  v_mfma_f32_32x32x16_bf16 v[60:75], v[40:43], v[248:251], v[60:75]
  s_add_u32 m0, s50, 81920
  s_nop 0
  buffer_load_dwordx4 v5, s[12:15], s66 offen lds
  buffer_load_dwordx4 v5, s[12:15], s67 offen offset:1024 lds
  s_add_u32 s66, s66, 0x78000
  s_add_u32 s67, s67, 0x78000
  ds_read_b64_tr_b16 v[32:33], v2 offset:34816
  ds_read_b64_tr_b16 v[34:35], v2 offset:35328
  ds_read_b64_tr_b16 v[36:37], v2 offset:36864
  ds_read_b64_tr_b16 v[38:39], v2 offset:37376
  s_waitcnt lgkmcnt(4)
  v_mfma_f32_32x32x16_bf16 v[76:91], v[28:31], v[92:95], 0
  ds_read_b64_tr_b16 v[28:29], v2 offset:38912
  ds_read_b64_tr_b16 v[30:31], v2 offset:39424
  s_waitcnt lgkmcnt(4)
  v_mfma_f32_32x32x16_bf16 v[76:91], v[32:35], v[96:99], v[76:91]
  ds_read_b128 v[20:23], v8 offset:256
  v_mul_f32 v24, v6, v6
  v_mul_f32 v19, s54, v6
  v_mul_f32 v24, v24, v6
  v_mul_f32 v9, v9, v24
  ds_read_b64_tr_b16 v[32:33], v2 offset:40960
  ds_read_b64_tr_b16 v[34:35], v2 offset:41472
  s_waitcnt lgkmcnt(5)
  v_mfma_f32_32x32x16_bf16 v[76:91], v[36:39], v[100:103], v[76:91]
  s_waitcnt lgkmcnt(2)
  v_fma_f32 v60, v20, v7, v60
  v_fma_f32 v61, v21, v7, v61
  v_fma_f32 v62, v22, v7, v62
  v_fma_f32 v63, v23, v7, v63
  ds_read_b128 v[20:23], v8 offset:288
  v_mul_f32 v24, v60, v60
  ds_read_b64_tr_b16 v[36:37], v2 offset:43008
  ds_read_b64_tr_b16 v[38:39], v2 offset:43520
  v_mfma_f32_32x32x16_bf16 v[76:91], v[28:31], v[104:107], v[76:91]
  v_mul_f32 v25, v61, v61
  v_mul_f32 v26, v62, v62
  v_mul_f32 v27, v63, v63
  v_fma_f32 v24, v24, v9, v19
  v_fma_f32 v25, v25, v9, v19
  v_fma_f32 v26, v26, v9, v19
  ds_read_b64_tr_b16 v[28:29], v2 offset:45056
  ds_read_b64_tr_b16 v[30:31], v2 offset:45568
  s_waitcnt lgkmcnt(5)
  v_mfma_f32_32x32x16_bf16 v[76:91], v[32:35], v[108:111], v[76:91]
  v_fma_f32 v27, v27, v9, v19
  v_mul_f32 v24, v60, v24
  v_mul_f32 v25, v61, v25
  v_mul_f32 v26, v62, v26
  v_mul_f32 v27, v63, v27
  v_exp_f32 v24, v24
  v_exp_f32 v25, v25
  ds_read_b64_tr_b16 v[32:33], v2 offset:47104
  ds_read_b64_tr_b16 v[34:35], v2 offset:47616
  s_waitcnt lgkmcnt(4)
  v_mfma_f32_32x32x16_bf16 v[76:91], v[36:39], v[112:115], v[76:91]
  v_exp_f32 v26, v26
  v_exp_f32 v27, v27
  v_add_f32 v24, 1.0, v24
  v_add_f32 v25, 1.0, v25
  v_add_f32 v26, 1.0, v26
  v_add_f32 v27, 1.0, v27
  s_waitcnt vmcnt(12)
  s_waitcnt lgkmcnt(0)
  s_barrier
  ds_read_b64_tr_b16 v[36:37], v3 offset:32768
  ds_read_b64_tr_b16 v[38:39], v3 offset:33280
  v_mfma_f32_32x32x16_bf16 v[76:91], v[28:31], v[116:119], v[76:91]
  s_add_u32 m0, s50, 32768
  s_nop 0
  buffer_load_dwordx4 v5, s[12:15], s66 offen lds
  buffer_load_dwordx4 v5, s[12:15], s67 offen offset:1024 lds
  s_add_u32 s66, s66, 0x78000
  s_add_u32 s67, s67, 0x78000
  v_rcp_f32 v24, v24
  v_rcp_f32 v25, v25
  v_rcp_f32 v26, v26
  v_rcp_f32 v27, v27
  ds_read_b64_tr_b16 v[28:29], v3 offset:34816
  ds_read_b64_tr_b16 v[30:31], v3 offset:35328
  v_mfma_f32_32x32x16_bf16 v[76:91], v[32:35], v[120:123], v[76:91]
  v_mul_f32 v60, v60, v24
  v_mul_f32 v61, v61, v25
  v_mul_f32 v62, v62, v26
  v_mul_f32 v63, v63, v27
  v_mov_b32 v16, v60
  v_mul_f32 v17, v60, v60
  v_add_f32 v16, v16, v61
  ds_read_b64_tr_b16 v[32:33], v3 offset:36864
  ds_read_b64_tr_b16 v[34:35], v3 offset:37376
  s_waitcnt lgkmcnt(4)
  v_mfma_f32_32x32x16_bf16 v[76:91], v[36:39], v[124:127], v[76:91]
  v_fmac_f32 v17, v61, v61
  v_add_f32 v16, v16, v62
  v_fmac_f32 v17, v62, v62
  v_add_f32 v16, v16, v63
  v_fmac_f32 v17, v63, v63
  v_fma_f32 v64, v20, v7, v64
  ds_read_b64_tr_b16 v[36:37], v3 offset:38912
  ds_read_b64_tr_b16 v[38:39], v3 offset:39424
  s_waitcnt lgkmcnt(4)
  v_mfma_f32_32x32x16_bf16 v[76:91], v[28:31], v[128:131], v[76:91]
  v_fma_f32 v65, v21, v7, v65
  v_fma_f32 v66, v22, v7, v66
  v_fma_f32 v67, v23, v7, v67
  ds_read_b128 v[20:23], v8 offset:320
  v_mul_f32 v24, v64, v64
  v_mul_f32 v25, v65, v65
  ds_read_b64_tr_b16 v[28:29], v3 offset:40960
  ds_read_b64_tr_b16 v[30:31], v3 offset:41472
  s_waitcnt lgkmcnt(5)
  v_mfma_f32_32x32x16_bf16 v[76:91], v[32:35], v[132:135], v[76:91]
  v_mul_f32 v26, v66, v66
  v_mul_f32 v27, v67, v67
  v_fma_f32 v24, v24, v9, v19
  v_fma_f32 v25, v25, v9, v19
  v_fma_f32 v26, v26, v9, v19
  v_fma_f32 v27, v27, v9, v19
  v_mul_f32 v24, v64, v24
  ds_read_b64_tr_b16 v[32:33], v3 offset:43008
  ds_read_b64_tr_b16 v[34:35], v3 offset:43520
  s_waitcnt lgkmcnt(5)
  v_mfma_f32_32x32x16_bf16 v[76:91], v[36:39], v[136:139], v[76:91]
  v_mul_f32 v25, v65, v25
  v_mul_f32 v26, v66, v26
  v_mul_f32 v27, v67, v27
  v_exp_f32 v24, v24
  v_exp_f32 v25, v25
  v_exp_f32 v26, v26
  ds_read_b64_tr_b16 v[36:37], v3 offset:45056
  ds_read_b64_tr_b16 v[38:39], v3 offset:45568
  s_waitcnt lgkmcnt(4)
  v_mfma_f32_32x32x16_bf16 v[76:91], v[28:31], v[140:143], v[76:91]
  v_exp_f32 v27, v27
  v_add_f32 v24, 1.0, v24
  v_add_f32 v25, 1.0, v25
  v_add_f32 v26, 1.0, v26
  v_add_f32 v27, 1.0, v27
  v_rcp_f32 v24, v24
  ds_read_b64_tr_b16 v[28:29], v3 offset:47104
  ds_read_b64_tr_b16 v[30:31], v3 offset:47616
  s_waitcnt lgkmcnt(4)
  v_mfma_f32_32x32x16_bf16 v[76:91], v[32:35], v[144:147], v[76:91]
  v_rcp_f32 v25, v25
  v_rcp_f32 v26, v26
  v_rcp_f32 v27, v27
  v_mul_f32 v64, v64, v24
  v_mul_f32 v65, v65, v25
  v_mul_f32 v66, v66, v26
  s_waitcnt vmcnt(8)
  s_waitcnt lgkmcnt(0)
  s_barrier
  ds_read_b64_tr_b16 v[32:33], v2 offset:49152
  ds_read_b64_tr_b16 v[34:35], v2 offset:49664
  v_mfma_f32_32x32x16_bf16 v[76:91], v[36:39], v[148:151], v[76:91]
  s_add_u32 m0, s50, 98304
  s_nop 0
  buffer_load_dwordx4 v5, s[12:15], s66 offen lds
  buffer_load_dwordx4 v5, s[12:15], s67 offen offset:1024 lds
  s_add_u32 s66, s66, 0x78000
  s_add_u32 s67, s67, 0x78000
  v_mul_f32 v67, v67, v27
  v_add_f32 v16, v16, v64
  v_fmac_f32 v17, v64, v64
  v_add_f32 v16, v16, v65
  v_fmac_f32 v17, v65, v65
  ds_read_b64_tr_b16 v[36:37], v2 offset:51200
  ds_read_b64_tr_b16 v[38:39], v2 offset:51712
  v_mfma_f32_32x32x16_bf16 v[76:91], v[28:31], v[152:155], v[76:91]
  v_and_b32 v4, 31, v1
  v_lshlrev_b32 v4, 7, v4
  s_mov_b32 exec_hi, 0
  global_load_dword v4, v4, s[64:65]
  s_mov_b32 exec_hi, -1
  v_add_f32 v16, v16, v66
  v_fmac_f32 v17, v66, v66
  v_add_f32 v16, v16, v67
  v_fmac_f32 v17, v67, v67
  ds_read_b64_tr_b16 v[28:29], v2 offset:53248
  ds_read_b64_tr_b16 v[30:31], v2 offset:53760
  s_waitcnt lgkmcnt(4)
  v_mfma_f32_32x32x16_bf16 v[76:91], v[32:35], v[156:159], v[76:91]
  v_fma_f32 v68, v20, v7, v68
  v_fma_f32 v69, v21, v7, v69
  v_fma_f32 v70, v22, v7, v70
  v_fma_f32 v71, v23, v7, v71
  ds_read_b128 v[20:23], v8 offset:352
  v_mul_f32 v24, v68, v68
  ds_read_b64_tr_b16 v[32:33], v2 offset:55296
  ds_read_b64_tr_b16 v[34:35], v2 offset:55808
  s_waitcnt lgkmcnt(5)
  v_mfma_f32_32x32x16_bf16 v[76:91], v[36:39], v[160:163], v[76:91]
  v_mul_f32 v25, v69, v69
  v_mul_f32 v26, v70, v70
  v_mul_f32 v27, v71, v71
  v_fma_f32 v24, v24, v9, v19
  v_fma_f32 v25, v25, v9, v19
  v_fma_f32 v26, v26, v9, v19
  v_fma_f32 v27, v27, v9, v19
  ds_read_b64_tr_b16 v[36:37], v2 offset:57344
  ds_read_b64_tr_b16 v[38:39], v2 offset:57856
  s_waitcnt lgkmcnt(5)
  v_mfma_f32_32x32x16_bf16 v[76:91], v[28:31], v[164:167], v[76:91]
  v_mul_f32 v24, v68, v24
  v_mul_f32 v25, v69, v25
  v_mul_f32 v26, v70, v26
  v_mul_f32 v27, v71, v27
  v_exp_f32 v24, v24
  v_exp_f32 v25, v25
  ds_read_b64_tr_b16 v[28:29], v2 offset:59392
  ds_read_b64_tr_b16 v[30:31], v2 offset:59904
  s_waitcnt lgkmcnt(4)
  v_mfma_f32_32x32x16_bf16 v[76:91], v[32:35], v[168:171], v[76:91]
  v_exp_f32 v26, v26
  v_exp_f32 v27, v27
  v_add_f32 v24, 1.0, v24
  v_add_f32 v25, 1.0, v25
  v_add_f32 v26, 1.0, v26
  v_add_f32 v27, 1.0, v27
  ds_read_b64_tr_b16 v[32:33], v2 offset:61440
  ds_read_b64_tr_b16 v[34:35], v2 offset:61952
  s_waitcnt lgkmcnt(4)
  v_mfma_f32_32x32x16_bf16 v[76:91], v[36:39], v[172:175], v[76:91]
  v_rcp_f32 v24, v24
  v_rcp_f32 v25, v25
  v_rcp_f32 v26, v26
  v_rcp_f32 v27, v27
  v_mul_f32 v68, v68, v24
  v_mul_f32 v69, v69, v25
  v_mul_f32 v70, v70, v26
  ds_read_b64_tr_b16 v[36:37], v2 offset:63488
  ds_read_b64_tr_b16 v[38:39], v2 offset:64000
  s_waitcnt lgkmcnt(4)
  v_mfma_f32_32x32x16_bf16 v[76:91], v[28:31], v[176:179], v[76:91]
  v_mul_f32 v71, v71, v27
  v_add_f32 v16, v16, v68
  v_fmac_f32 v17, v68, v68
  v_add_f32 v16, v16, v69
  v_fmac_f32 v17, v69, v69
  v_add_f32 v16, v16, v70
  ds_read_b64_tr_b16 v[28:29], v3 offset:49152
  ds_read_b64_tr_b16 v[30:31], v3 offset:49664
  s_waitcnt lgkmcnt(4)
  v_mfma_f32_32x32x16_bf16 v[76:91], v[32:35], v[180:183], v[76:91]
  v_fmac_f32 v17, v70, v70
  v_add_f32 v16, v16, v71
  v_fmac_f32 v17, v71, v71
  v_fma_f32 v72, v20, v7, v72
  v_fma_f32 v73, v21, v7, v73
  v_fma_f32 v74, v22, v7, v74
  ds_read_b64_tr_b16 v[32:33], v3 offset:51200
  ds_read_b64_tr_b16 v[34:35], v3 offset:51712
  s_waitcnt lgkmcnt(4)
  v_mfma_f32_32x32x16_bf16 v[76:91], v[36:39], v[184:187], v[76:91]
  v_fma_f32 v75, v23, v7, v75
  v_mul_f32 v24, v72, v72
  v_mul_f32 v25, v73, v73
  v_mul_f32 v26, v74, v74
  v_mul_f32 v27, v75, v75
  v_fma_f32 v24, v24, v9, v19
  ds_read_b64_tr_b16 v[36:37], v3 offset:53248
  ds_read_b64_tr_b16 v[38:39], v3 offset:53760
  s_waitcnt lgkmcnt(4)
  v_mfma_f32_32x32x16_bf16 v[76:91], v[28:31], v[188:191], v[76:91]
  v_fma_f32 v25, v25, v9, v19
  v_fma_f32 v26, v26, v9, v19
  v_fma_f32 v27, v27, v9, v19
  v_mul_f32 v24, v72, v24
  v_mul_f32 v25, v73, v25
  v_mul_f32 v26, v74, v26
  v_mul_f32 v27, v75, v27
  ds_read_b64_tr_b16 v[28:29], v3 offset:55296
  ds_read_b64_tr_b16 v[30:31], v3 offset:55808
  s_waitcnt lgkmcnt(4)
  v_mfma_f32_32x32x16_bf16 v[76:91], v[32:35], v[192:195], v[76:91]
  v_exp_f32 v24, v24
  v_exp_f32 v25, v25
  v_exp_f32 v26, v26
  v_exp_f32 v27, v27
  v_add_f32 v24, 1.0, v24
  v_add_f32 v25, 1.0, v25
  ds_read_b64_tr_b16 v[32:33], v3 offset:57344
  ds_read_b64_tr_b16 v[34:35], v3 offset:57856
  s_waitcnt lgkmcnt(4)
  v_mfma_f32_32x32x16_bf16 v[76:91], v[36:39], v[196:199], v[76:91]
  v_add_f32 v26, 1.0, v26
  v_add_f32 v27, 1.0, v27
  v_rcp_f32 v24, v24
  v_rcp_f32 v25, v25
  v_rcp_f32 v26, v26
  v_rcp_f32 v27, v27
  ds_read_b64_tr_b16 v[36:37], v3 offset:59392
  ds_read_b64_tr_b16 v[38:39], v3 offset:59904
  s_waitcnt lgkmcnt(4)
  v_mfma_f32_32x32x16_bf16 v[76:91], v[28:31], v[200:203], v[76:91]
  v_mul_f32 v72, v72, v24
  v_mul_f32 v73, v73, v25
  v_mul_f32 v74, v74, v26
  v_mul_f32 v75, v75, v27
  ds_read_b128 v[20:23], v8 offset:0
  ds_read_b128 v[24:27], v8 offset:32
  v_add_f32 v16, v16, v72
  ds_read_b64_tr_b16 v[28:29], v3 offset:61440
  ds_read_b64_tr_b16 v[30:31], v3 offset:61952
  s_waitcnt lgkmcnt(6)
  v_mfma_f32_32x32x16_bf16 v[76:91], v[32:35], v[204:207], v[76:91]
  v_fmac_f32 v17, v72, v72
  v_add_f32 v16, v16, v73
  v_fmac_f32 v17, v73, v73
  v_add_f32 v16, v16, v74
  v_fmac_f32 v17, v74, v74
  v_add_f32 v16, v16, v75
  ds_read_b64_tr_b16 v[32:33], v3 offset:63488
  ds_read_b64_tr_b16 v[34:35], v3 offset:64000
  s_waitcnt lgkmcnt(6)
  v_mfma_f32_32x32x16_bf16 v[76:91], v[36:39], v[208:211], v[76:91]
  v_fmac_f32 v17, v75, v75
  v_mul_f32 v17, v17, v6
  v_mul_f32 v16, v16, v6
  v_mul_f32 v17, v17, v6
  v_mov_b32 v40, v16
  v_mov_b32 v41, v17
  ds_read_b64_tr_b16 v[36:37], v2 offset:0
  ds_read_b64_tr_b16 v[38:39], v2 offset:512
  s_waitcnt lgkmcnt(4)
  v_mfma_f32_32x32x16_bf16 v[76:91], v[28:31], v[212:215], v[76:91]
  v_mov_b32 v42, s60
  v_permlane32_swap_b32 v16, v40
  v_permlane32_swap_b32 v17, v41
  v_mov_b32 v43, s61
  v_add_f32 v16, v16, v40
  v_add_f32 v17, v17, v41
  v_and_b32 v16, s70, v16
  ds_read_b64_tr_b16 v[28:29], v2 offset:2048
  ds_read_b64_tr_b16 v[30:31], v2 offset:2560
  s_waitcnt lgkmcnt(4)
  v_mfma_f32_32x32x16_bf16 v[76:91], v[32:35], v[216:219], v[76:91]
  v_and_b32 v17, s70, v17
  ds_write_b64 v18, v[16:17]
  v_xor_b32 v18, 1024, v18
  v_fma_f32 v44, v20, v7, v44
  v_fma_f32 v45, v21, v7, v45
  v_fma_f32 v46, v22, v7, v46
  ds_read_b64_tr_b16 v[32:33], v2 offset:4096
  ds_read_b64_tr_b16 v[34:35], v2 offset:4608
  s_waitcnt lgkmcnt(5)
  v_mfma_f32_32x32x16_bf16 v[76:91], v[36:39], v[220:223], v[76:91]
  v_fma_f32 v47, v23, v7, v47
  v_mul_f32 v44, v44, v6
  v_mul_f32 v45, v45, v6
  v_mul_f32 v46, v46, v6
  v_mul_f32 v47, v47, v6
  ds_read_b128 v[20:23], v8 offset:64
  ds_read_b64_tr_b16 v[36:37], v2 offset:6144
  ds_read_b64_tr_b16 v[38:39], v2 offset:6656
  s_waitcnt lgkmcnt(6)
  v_mfma_f32_32x32x16_bf16 v[76:91], v[28:31], v[224:227], v[76:91]
  v_cvt_pk_bf16_f32 v44, v44, v45
  v_cvt_pk_bf16_f32 v45, v46, v47
  v_fma_f32 v48, v24, v7, v48
  s_waitcnt lgkmcnt(5)
  s_barrier
  ds_read_b64 v[40:41], v18
  v_fma_f32 v49, v25, v7, v49
  v_fma_f32 v50, v26, v7, v50
  ds_read_b64_tr_b16 v[28:29], v2 offset:8192
  ds_read_b64_tr_b16 v[30:31], v2 offset:8704
  s_waitcnt lgkmcnt(6)
  v_mfma_f32_32x32x16_bf16 v[76:91], v[32:35], v[228:231], v[76:91]
  v_fma_f32 v51, v27, v7, v51
  v_mul_f32 v48, v48, v6
  v_mul_f32 v49, v49, v6
  v_mul_f32 v50, v50, v6
  v_mul_f32 v51, v51, v6
  ds_read_b128 v[24:27], v8 offset:96
  s_waitcnt lgkmcnt(3)
  v_add_f32 v40, v40, v16
  ds_read_b64_tr_b16 v[32:33], v2 offset:10240
  ds_read_b64_tr_b16 v[34:35], v2 offset:10752
  v_mfma_f32_32x32x16_bf16 v[76:91], v[36:39], v[232:235], v[76:91]
  v_add_f32 v41, v41, v17
  buffer_store_dwordx4 v[40:43], v14, s[16:19], s68 offen sc1
  v_cvt_pk_bf16_f32 v46, v48, v49
  v_cvt_pk_bf16_f32 v47, v50, v51
  buffer_store_dwordx4 v[44:47], v10, s[16:19], s58 offen offset:0 sc1
  v_fma_f32 v52, v20, v7, v52
  ds_read_b64_tr_b16 v[36:37], v2 offset:12288
  ds_read_b64_tr_b16 v[38:39], v2 offset:12800
  s_waitcnt lgkmcnt(5)
  v_mfma_f32_32x32x16_bf16 v[76:91], v[28:31], v[236:239], v[76:91]
  v_fma_f32 v53, v21, v7, v53
  v_fma_f32 v54, v22, v7, v54
  v_fma_f32 v55, v23, v7, v55
  v_mul_f32 v52, v52, v6
  v_mul_f32 v53, v53, v6
  v_mul_f32 v54, v54, v6
  ds_read_b64_tr_b16 v[28:29], v2 offset:14336
  ds_read_b64_tr_b16 v[30:31], v2 offset:14848
  s_waitcnt lgkmcnt(4)
  v_mfma_f32_32x32x16_bf16 v[76:91], v[32:35], v[240:243], v[76:91]
  v_mul_f32 v55, v55, v6
  v_cvt_pk_bf16_f32 v52, v52, v53
  v_cvt_pk_bf16_f32 v53, v54, v55
  v_fma_f32 v56, v24, v7, v56
  v_fma_f32 v57, v25, v7, v57
  v_fma_f32 v58, v26, v7, v58
  v_fma_f32 v59, v27, v7, v59
  s_waitcnt vmcnt(3)
  s_barrier
  ds_read_b64_tr_b16 v[32:33], v3 offset:0
  ds_read_b64_tr_b16 v[34:35], v3 offset:512
  s_waitcnt lgkmcnt(4)
  v_mfma_f32_32x32x16_bf16 v[76:91], v[36:39], v[244:247], v[76:91]
  v_mul_f32 v56, v56, v6
  v_mul_f32 v57, v57, v6
  v_mul_f32 v58, v58, v6
  v_mul_f32 v59, v59, v6
  v_cvt_pk_bf16_f32 v54, v56, v57
  v_cvt_pk_bf16_f32 v55, v58, v59
  ds_read_b64_tr_b16 v[36:37], v3 offset:2048
  ds_read_b64_tr_b16 v[38:39], v3 offset:2560
  s_waitcnt lgkmcnt(4)
  v_mfma_f32_32x32x16_bf16 v[76:91], v[28:31], v[248:251], v[76:91]
  buffer_store_dwordx4 v[52:55], v10, s[16:19], s58 offen offset:512 sc1
  ds_read_b64_tr_b16 v[28:29], v3 offset:4096
  ds_read_b64_tr_b16 v[30:31], v3 offset:4608
  s_waitcnt lgkmcnt(4)
  v_mfma_f32_32x32x16_bf16 v[44:59], v[32:35], v[92:95], 0
  ds_read_b64_tr_b16 v[32:33], v3 offset:6144
  ds_read_b64_tr_b16 v[34:35], v3 offset:6656
  s_waitcnt lgkmcnt(4)
  v_mfma_f32_32x32x16_bf16 v[44:59], v[36:39], v[96:99], v[44:59]
  ds_read_b128 v[20:23], v8 offset:512
  ds_read_b128 v[24:27], v8 offset:544
  ds_read_b64_tr_b16 v[36:37], v3 offset:8192
  ds_read_b64_tr_b16 v[38:39], v3 offset:8704
  s_waitcnt lgkmcnt(6)
  v_mfma_f32_32x32x16_bf16 v[44:59], v[28:31], v[100:103], v[44:59]
  s_waitcnt lgkmcnt(3)
  v_fma_f32 v76, v20, v7, v76
  v_fma_f32 v77, v21, v7, v77
  v_fma_f32 v78, v22, v7, v78
  v_fma_f32 v79, v23, v7, v79
  v_mul_f32 v76, v76, v6
  ds_read_b64_tr_b16 v[28:29], v3 offset:10240
  ds_read_b64_tr_b16 v[30:31], v3 offset:10752
  v_mfma_f32_32x32x16_bf16 v[44:59], v[32:35], v[104:107], v[44:59]
  v_mul_f32 v77, v77, v6
  v_mul_f32 v78, v78, v6
  v_mul_f32 v79, v79, v6
  ds_read_b128 v[20:23], v8 offset:576
  v_cvt_pk_bf16_f32 v76, v76, v77
  ds_read_b64_tr_b16 v[32:33], v3 offset:12288
  ds_read_b64_tr_b16 v[34:35], v3 offset:12800
  s_waitcnt lgkmcnt(5)
  v_mfma_f32_32x32x16_bf16 v[44:59], v[36:39], v[108:111], v[44:59]
  v_cvt_pk_bf16_f32 v77, v78, v79
  v_fma_f32 v80, v24, v7, v80
  v_fma_f32 v81, v25, v7, v81
  v_fma_f32 v82, v26, v7, v82
  v_fma_f32 v83, v27, v7, v83
  ds_read_b64_tr_b16 v[36:37], v3 offset:14336
  ds_read_b64_tr_b16 v[38:39], v3 offset:14848
  s_waitcnt lgkmcnt(5)
  v_mfma_f32_32x32x16_bf16 v[44:59], v[28:31], v[112:115], v[44:59]
  v_mul_f32 v80, v80, v6
  v_mul_f32 v81, v81, v6
  v_mul_f32 v82, v82, v6
  v_mul_f32 v83, v83, v6
  ds_read_b128 v[24:27], v8 offset:608
  ds_read_b64_tr_b16 v[28:29], v2 offset:16384
  ds_read_b64_tr_b16 v[30:31], v2 offset:16896
  s_waitcnt lgkmcnt(5)
  v_mfma_f32_32x32x16_bf16 v[44:59], v[32:35], v[116:119], v[44:59]
  v_cvt_pk_bf16_f32 v80, v80, v81
  v_cvt_pk_bf16_f32 v81, v82, v83
  v_fma_f32 v84, v20, v7, v84
  v_fma_f32 v85, v21, v7, v85
  v_fma_f32 v86, v22, v7, v86
  ds_read_b64_tr_b16 v[32:33], v2 offset:18432
  ds_read_b64_tr_b16 v[34:35], v2 offset:18944
  s_waitcnt lgkmcnt(5)
  v_mfma_f32_32x32x16_bf16 v[44:59], v[36:39], v[120:123], v[44:59]
  v_fma_f32 v87, v23, v7, v87
  v_mul_f32 v84, v84, v6
  v_mul_f32 v85, v85, v6
  v_mul_f32 v86, v86, v6
  v_mul_f32 v87, v87, v6
  ds_read_b64_tr_b16 v[36:37], v2 offset:20480
  ds_read_b64_tr_b16 v[38:39], v2 offset:20992
  s_waitcnt lgkmcnt(4)
  v_mfma_f32_32x32x16_bf16 v[44:59], v[28:31], v[124:127], v[44:59]
  v_cvt_pk_bf16_f32 v84, v84, v85
  v_cvt_pk_bf16_f32 v85, v86, v87
  v_fma_f32 v88, v24, v7, v88
  v_fma_f32 v89, v25, v7, v89
  v_fma_f32 v90, v26, v7, v90
  ds_read_b64_tr_b16 v[28:29], v2 offset:22528
  ds_read_b64_tr_b16 v[30:31], v2 offset:23040
  s_waitcnt lgkmcnt(4)
  v_mfma_f32_32x32x16_bf16 v[44:59], v[32:35], v[128:131], v[44:59]
  v_fma_f32 v91, v27, v7, v91
  v_mul_f32 v88, v88, v6
  v_mul_f32 v89, v89, v6
  v_mul_f32 v90, v90, v6
  v_mul_f32 v91, v91, v6
  ds_read_b64_tr_b16 v[32:33], v2 offset:24576
  ds_read_b64_tr_b16 v[34:35], v2 offset:25088
  s_waitcnt lgkmcnt(4)
  v_mfma_f32_32x32x16_bf16 v[44:59], v[36:39], v[132:135], v[44:59]
  v_cvt_pk_bf16_f32 v88, v88, v89
  v_cvt_pk_bf16_f32 v89, v90, v91
  ds_read_b64_tr_b16 v[36:37], v2 offset:26624
  ds_read_b64_tr_b16 v[38:39], v2 offset:27136
  s_waitcnt lgkmcnt(4)
  v_mfma_f32_32x32x16_bf16 v[44:59], v[28:31], v[136:139], v[44:59]
  ds_read_b64_tr_b16 v[28:29], v2 offset:28672
  ds_read_b64_tr_b16 v[30:31], v2 offset:29184
  s_waitcnt lgkmcnt(4)
  v_mfma_f32_32x32x16_bf16 v[44:59], v[32:35], v[140:143], v[44:59]
  ds_read_b64_tr_b16 v[32:33], v2 offset:30720
  ds_read_b64_tr_b16 v[34:35], v2 offset:31232
  s_waitcnt lgkmcnt(4)
  v_mfma_f32_32x32x16_bf16 v[44:59], v[36:39], v[144:147], v[44:59]
  ds_read_b64_tr_b16 v[36:37], v3 offset:16384
  ds_read_b64_tr_b16 v[38:39], v3 offset:16896
  s_waitcnt lgkmcnt(4)
  v_mfma_f32_32x32x16_bf16 v[44:59], v[28:31], v[148:151], v[44:59]
  v_lshlrev_b32 v120, 4, v1
  buffer_load_dwordx4 v[92:95], v120, s[16:19], s68 offen offset:0 sc1
  buffer_load_dwordx4 v[96:99], v120, s[16:19], s68 offen offset:1024 sc1
  ds_read_b64_tr_b16 v[28:29], v3 offset:18432
  ds_read_b64_tr_b16 v[30:31], v3 offset:18944
  s_waitcnt lgkmcnt(4)
  v_mfma_f32_32x32x16_bf16 v[44:59], v[32:35], v[152:155], v[44:59]
  buffer_load_dwordx4 v[100:103], v120, s[16:19], s68 offen offset:2048 sc1
  buffer_load_dwordx4 v[104:107], v120, s[16:19], s68 offen offset:3072 sc1
  ds_read_b64_tr_b16 v[32:33], v3 offset:20480
  ds_read_b64_tr_b16 v[34:35], v3 offset:20992
  s_waitcnt lgkmcnt(4)
  v_mfma_f32_32x32x16_bf16 v[44:59], v[36:39], v[156:159], v[44:59]
  buffer_load_dwordx4 v[108:111], v120, s[16:19], s69 offen offset:0 sc1
  buffer_load_dwordx4 v[112:115], v120, s[16:19], s69 offen offset:1024 sc1
  ds_read_b64_tr_b16 v[36:37], v3 offset:22528
  ds_read_b64_tr_b16 v[38:39], v3 offset:23040
  s_waitcnt lgkmcnt(4)
  v_mfma_f32_32x32x16_bf16 v[44:59], v[28:31], v[160:163], v[44:59]
  buffer_load_dwordx4 v[116:119], v120, s[16:19], s69 offen offset:2048 sc1
  ds_read_b64_tr_b16 v[28:29], v3 offset:24576
  ds_read_b64_tr_b16 v[30:31], v3 offset:25088
  s_waitcnt lgkmcnt(4)
  v_mfma_f32_32x32x16_bf16 v[44:59], v[32:35], v[164:167], v[44:59]
  buffer_store_dwordx2 v[76:77], v11, s[16:19], s55 offen sc1
  s_add_u32 s55, s55, 32768
  ds_read_b64_tr_b16 v[32:33], v3 offset:26624
  ds_read_b64_tr_b16 v[34:35], v3 offset:27136
  s_waitcnt lgkmcnt(4)
  v_mfma_f32_32x32x16_bf16 v[44:59], v[36:39], v[168:171], v[44:59]
  buffer_store_dwordx2 v[80:81], v11, s[16:19], s55 offen sc1
  s_add_u32 s55, s55, 32768
  ds_read_b64_tr_b16 v[36:37], v3 offset:28672
  ds_read_b64_tr_b16 v[38:39], v3 offset:29184
  s_waitcnt lgkmcnt(4)
  v_mfma_f32_32x32x16_bf16 v[44:59], v[28:31], v[172:175], v[44:59]
  buffer_store_dwordx2 v[84:85], v11, s[16:19], s55 offen sc1
  s_add_u32 s55, s55, 32768
  ds_read_b64_tr_b16 v[28:29], v3 offset:30720
  ds_read_b64_tr_b16 v[30:31], v3 offset:31232
  s_waitcnt lgkmcnt(4)
  v_mfma_f32_32x32x16_bf16 v[44:59], v[32:35], v[176:179], v[44:59]
  buffer_store_dwordx2 v[88:89], v11, s[16:19], s55 offen sc1
  s_add_u32 s55, s55, 163840
  ds_read_b64_tr_b16 v[32:33], v2 offset:32768
  ds_read_b64_tr_b16 v[34:35], v2 offset:33280
  s_waitcnt lgkmcnt(4)
  v_mfma_f32_32x32x16_bf16 v[44:59], v[36:39], v[180:183], v[44:59]
  ds_read_b64_tr_b16 v[36:37], v2 offset:34816
  ds_read_b64_tr_b16 v[38:39], v2 offset:35328
  s_waitcnt lgkmcnt(4)
  v_mfma_f32_32x32x16_bf16 v[44:59], v[28:31], v[184:187], v[44:59]
  ds_read_b64_tr_b16 v[28:29], v2 offset:36864
  ds_read_b64_tr_b16 v[30:31], v2 offset:37376
  s_waitcnt lgkmcnt(4)
  v_mfma_f32_32x32x16_bf16 v[44:59], v[32:35], v[188:191], v[44:59]
  s_waitcnt vmcnt(10)
  v_cmp_ne_u64 s[36:37], s[60:61], v[94:95]
  s_waitcnt vmcnt(9)
  v_cmp_ne_u64 s[38:39], s[60:61], v[98:99]
  s_waitcnt vmcnt(8)
  v_cmp_ne_u64 s[40:41], s[60:61], v[102:103]
  s_waitcnt vmcnt(7)
  v_cmp_ne_u64 s[42:43], s[60:61], v[106:107]
  s_waitcnt vmcnt(6)
  v_cmp_ne_u64 s[44:45], s[60:61], v[110:111]
  s_waitcnt vmcnt(5)
  v_cmp_ne_u64 s[46:47], s[60:61], v[114:115]
  ds_read_b64_tr_b16 v[32:33], v2 offset:38912
  ds_read_b64_tr_b16 v[34:35], v2 offset:39424
  s_waitcnt lgkmcnt(4)
  v_mfma_f32_32x32x16_bf16 v[44:59], v[36:39], v[192:195], v[44:59]
  s_waitcnt vmcnt(4)
  v_cmp_ne_u64 s[48:49], s[60:61], v[118:119]
  s_or_b64 s[36:37], s[36:37], s[38:39]
  s_or_b64 s[36:37], s[36:37], s[40:41]
  s_or_b64 s[36:37], s[36:37], s[42:43]
  s_or_b64 s[36:37], s[36:37], s[44:45]
  s_or_b64 s[36:37], s[36:37], s[46:47]
  s_or_b64 s[36:37], s[36:37], s[48:49]
  s_cmp_lg_u64 s[36:37], 0
  s_cbranch_scc1 P1_zspin
P1_zok:
  v_add_f32 v92, v92, v96
  v_add_f32 v93, v93, v97
  v_add_f32 v100, v100, v104
  ds_read_b64_tr_b16 v[36:37], v2 offset:40960
  ds_read_b64_tr_b16 v[38:39], v2 offset:41472
  s_waitcnt lgkmcnt(4)
  v_mfma_f32_32x32x16_bf16 v[44:59], v[28:31], v[196:199], v[44:59]
  v_add_f32 v101, v101, v105
  v_add_f32 v108, v108, v112
  v_add_f32 v109, v109, v113
  v_add_f32 v92, v92, v100
  v_add_f32 v93, v93, v101
  v_add_f32 v108, v108, v116
  ds_read_b64_tr_b16 v[28:29], v2 offset:43008
  ds_read_b64_tr_b16 v[30:31], v2 offset:43520
  s_waitcnt lgkmcnt(4)
  v_mfma_f32_32x32x16_bf16 v[44:59], v[32:35], v[200:203], v[44:59]
  v_add_f32 v109, v109, v117
  v_add_f32 v92, v92, v108
  v_add_f32 v93, v93, v109
  v_mov_b32 v94, v92
  v_mov_b32 v95, v93
  v_mov_b32 v96, 0x3727c5ac
  ds_read_b64_tr_b16 v[32:33], v2 offset:45056
  ds_read_b64_tr_b16 v[34:35], v2 offset:45568
  s_waitcnt lgkmcnt(4)
  v_mfma_f32_32x32x16_bf16 v[44:59], v[36:39], v[204:207], v[44:59]
  v_permlane32_swap_b32 v92, v94
  v_permlane32_swap_b32 v93, v95
  v_add_f32 v92, v92, v94
  v_add_f32 v93, v93, v95
  v_mul_f32 v92, 0x3a97b426, v92
  v_mul_f32 v93, 0x3a97b426, v93
  ds_read_b64_tr_b16 v[36:37], v2 offset:47104
  ds_read_b64_tr_b16 v[38:39], v2 offset:47616
  s_waitcnt lgkmcnt(4)
  v_mfma_f32_32x32x16_bf16 v[44:59], v[28:31], v[208:211], v[44:59]
  v_fma_f32 v93, -v92, v92, v93
  v_max_f32 v93, 0, v93
  v_add_f32 v93, v96, v93
  v_rsq_f32 v93, v93
  v_lshlrev_b32 v97, 4, v1
  v_or_b32 v97, s57, v97
  ds_read_b64_tr_b16 v[28:29], v3 offset:32768
  ds_read_b64_tr_b16 v[30:31], v3 offset:33280
  s_waitcnt lgkmcnt(4)
  v_mfma_f32_32x32x16_bf16 v[44:59], v[32:35], v[212:215], v[44:59]
  v_mul_f32 v92, v92, v93
  v_mul_f32 v93, v93, v6
  v_fma_f32 v60, v60, v93, -v92
  v_fma_f32 v61, v61, v93, -v92
  v_fma_f32 v62, v62, v93, -v92
  v_fma_f32 v63, v63, v93, -v92
  ds_read_b64_tr_b16 v[32:33], v3 offset:34816
  ds_read_b64_tr_b16 v[34:35], v3 offset:35328
  s_waitcnt lgkmcnt(4)
  v_mfma_f32_32x32x16_bf16 v[44:59], v[36:39], v[216:219], v[44:59]
  v_cvt_pk_bf16_f32 v60, v60, v61
  v_cvt_pk_bf16_f32 v61, v62, v63
  ds_write_b64 v12, v[60:61]
  v_fma_f32 v64, v64, v93, -v92
  v_fma_f32 v65, v65, v93, -v92
  v_fma_f32 v66, v66, v93, -v92
  ds_read_b64_tr_b16 v[36:37], v3 offset:36864
  ds_read_b64_tr_b16 v[38:39], v3 offset:37376
  s_waitcnt lgkmcnt(5)
  v_mfma_f32_32x32x16_bf16 v[44:59], v[28:31], v[220:223], v[44:59]
  v_fma_f32 v67, v67, v93, -v92
  v_cvt_pk_bf16_f32 v62, v64, v65
  v_cvt_pk_bf16_f32 v63, v66, v67
  v_xor_b32 v98, 16, v12
  ds_write_b64 v98, v[62:63]
  v_fma_f32 v68, v68, v93, -v92
  ds_read_b64_tr_b16 v[28:29], v3 offset:38912
  ds_read_b64_tr_b16 v[30:31], v3 offset:39424
  s_waitcnt lgkmcnt(6)
  v_mfma_f32_32x32x16_bf16 v[44:59], v[32:35], v[224:227], v[44:59]
  v_fma_f32 v69, v69, v93, -v92
  v_fma_f32 v70, v70, v93, -v92
  v_fma_f32 v71, v71, v93, -v92
  v_cvt_pk_bf16_f32 v64, v68, v69
  v_cvt_pk_bf16_f32 v65, v70, v71
  v_xor_b32 v98, 32, v12
  ds_read_b64_tr_b16 v[32:33], v3 offset:40960
  ds_read_b64_tr_b16 v[34:35], v3 offset:41472
  s_waitcnt lgkmcnt(5)
  v_mfma_f32_32x32x16_bf16 v[44:59], v[36:39], v[228:231], v[44:59]
  ds_write_b64 v98, v[64:65]
  v_fma_f32 v72, v72, v93, -v92
  v_fma_f32 v73, v73, v93, -v92
  v_fma_f32 v74, v74, v93, -v92
  v_fma_f32 v75, v75, v93, -v92
  v_cvt_pk_bf16_f32 v66, v72, v73
  ds_read_b64_tr_b16 v[36:37], v3 offset:43008
  ds_read_b64_tr_b16 v[38:39], v3 offset:43520
  s_waitcnt lgkmcnt(5)
  v_mfma_f32_32x32x16_bf16 v[44:59], v[28:31], v[232:235], v[44:59]
  v_cvt_pk_bf16_f32 v67, v74, v75
  v_xor_b32 v98, 48, v12
  ds_write_b64 v98, v[66:67]
  ds_read_b64_tr_b16 v[68:69], v13 offset:0
  ds_read_b64_tr_b16 v[70:71], v13 offset:288
  ds_read_b64_tr_b16 v[72:73], v13 offset:32
  ds_read_b64_tr_b16 v[28:29], v3 offset:45056
  ds_read_b64_tr_b16 v[30:31], v3 offset:45568
  s_waitcnt lgkmcnt(9)
  v_mfma_f32_32x32x16_bf16 v[44:59], v[32:35], v[236:239], v[44:59]
  ds_read_b64_tr_b16 v[74:75], v13 offset:256
  ds_read_b64_tr_b16 v[32:33], v3 offset:47104
  ds_read_b64_tr_b16 v[34:35], v3 offset:47616
  s_waitcnt lgkmcnt(9)
  v_mfma_f32_32x32x16_bf16 v[44:59], v[36:39], v[240:243], v[44:59]
  s_waitcnt lgkmcnt(3)
  v_mfma_f32_32x32x16_bf16 v[44:59], v[28:31], v[244:247], v[44:59]
  buffer_store_dwordx4 v[68:71], v97, s[16:19], s56 offen offset:0 sc1
  s_waitcnt lgkmcnt(2)
  buffer_store_dwordx4 v[72:75], v97, s[16:19], s56 offen offset:1024 sc1
  s_waitcnt lgkmcnt(0)
  v_mfma_f32_32x32x16_bf16 v[44:59], v[32:35], v[248:251], v[44:59]
  ds_read_b128 v[20:23], v8 offset:768
  ds_read_b128 v[24:27], v8 offset:800
  s_waitcnt lgkmcnt(1)
  s_nop 8
  v_fma_f32 v44, v20, v7, v44
  v_fma_f32 v45, v21, v7, v45
  v_fma_f32 v46, v22, v7, v46
  v_fma_f32 v47, v23, v7, v47
  v_mul_f32 v44, v44, v6
  v_mul_f32 v45, v45, v6
  v_mul_f32 v46, v46, v6
  v_mul_f32 v47, v47, v6
  ds_read_b128 v[20:23], v8 offset:832
  v_cvt_pk_bf16_f32 v44, v44, v45
  v_cvt_pk_bf16_f32 v45, v46, v47
  buffer_store_dwordx2 v[44:45], v11, s[16:19], s55 offen sc1
  s_add_u32 s55, s55, 32768
  s_waitcnt lgkmcnt(1)
  v_fma_f32 v48, v24, v7, v48
  v_fma_f32 v49, v25, v7, v49
  v_fma_f32 v50, v26, v7, v50
  v_fma_f32 v51, v27, v7, v51
  v_mul_f32 v48, v48, v6
  v_mul_f32 v49, v49, v6
  v_mul_f32 v50, v50, v6
  v_mul_f32 v51, v51, v6
  ds_read_b128 v[24:27], v8 offset:864
  v_cvt_pk_bf16_f32 v48, v48, v49
  v_cvt_pk_bf16_f32 v49, v50, v51
  buffer_store_dwordx2 v[48:49], v11, s[16:19], s55 offen sc1
  s_add_u32 s55, s55, 32768
  s_waitcnt lgkmcnt(1)
  v_fma_f32 v52, v20, v7, v52
  v_fma_f32 v53, v21, v7, v53
  v_fma_f32 v54, v22, v7, v54
  v_fma_f32 v55, v23, v7, v55
  v_mul_f32 v52, v52, v6
  v_mul_f32 v53, v53, v6
  v_mul_f32 v54, v54, v6
  v_mul_f32 v55, v55, v6
  v_cvt_pk_bf16_f32 v52, v52, v53
  v_cvt_pk_bf16_f32 v53, v54, v55
  buffer_store_dwordx2 v[52:53], v11, s[16:19], s55 offen sc1
  s_add_u32 s55, s55, 32768
  s_waitcnt lgkmcnt(0)
  v_fma_f32 v56, v24, v7, v56
  v_fma_f32 v57, v25, v7, v57
  v_fma_f32 v58, v26, v7, v58
  v_fma_f32 v59, v27, v7, v59
  v_mul_f32 v56, v56, v6
  v_mul_f32 v57, v57, v6
  v_mul_f32 v58, v58, v6
  v_mul_f32 v59, v59, v6
  v_cvt_pk_bf16_f32 v56, v56, v57
  v_cvt_pk_bf16_f32 v57, v58, v59
  buffer_store_dwordx2 v[56:57], v11, s[16:19], s55 offen sc1
  s_add_u32 s55, s55, 163840
  s_branch P1_done
P1_nspin:
  s_mov_b32 s62, 200000
P1_nspin_l:
  s_waitcnt vmcnt(0)
  v_readfirstlane_b32 s60, v208
  v_readfirstlane_b32 s61, v209
  s_nop 2
  s_cmp_lg_u32 s60, 0
  s_cbranch_scc1 P1_nok
  buffer_load_dwordx2 v[208:209], v240, s[20:23], 0 offen sc1
  s_sub_u32 s62, s62, 1
  s_cmp_lg_u32 s62, 0
  s_cbranch_scc1 P1_nspin_l
  s_waitcnt vmcnt(0)
  s_branch P1_nok
P1_gspin:
  s_mov_b32 s62, 200000
P1_gspin_l:
  buffer_load_dwordx4 v[80:83], v16, s[16:19], s44 offen sc1
  buffer_load_dwordx4 v[20:23], v17, s[16:19], s43 offen offset:0 sc1
  buffer_load_dwordx4 v[24:27], v17, s[16:19], s43 offen offset:1024 sc1
  buffer_load_dwordx4 v[84:87], v17, s[16:19], s43 offen offset:2048 sc1
  buffer_load_dwordx4 v[88:91], v17, s[16:19], s43 offen offset:3072 sc1
  s_waitcnt vmcnt(0)
  v_cmp_ne_u64 vcc, s[60:61], v[82:83]
  s_nop 3
  s_mov_b64 s[52:53], vcc
  v_cmp_ne_u64 vcc, s[60:61], v[22:23]
  s_nop 3
  s_or_b64 s[52:53], s[52:53], vcc
  v_cmp_ne_u64 vcc, s[60:61], v[26:27]
  s_nop 3
  s_or_b64 s[52:53], s[52:53], vcc
  v_cmp_ne_u64 vcc, s[60:61], v[86:87]
  s_nop 3
  s_or_b64 s[52:53], s[52:53], vcc
  v_cmp_ne_u64 vcc, s[60:61], v[90:91]
  s_nop 3
  s_or_b64 s[52:53], s[52:53], vcc
  s_cmp_lg_u64 s[52:53], 0
  s_cbranch_scc0 P1_gok
  s_sub_u32 s62, s62, 1
  s_cmp_lg_u32 s62, 0
  s_cbranch_scc1 P1_gspin_l
  s_branch P1_gok
P1_zspin:
  s_mov_b32 s62, 200000
P1_zspin_l:
  buffer_load_dwordx4 v[92:95], v120, s[16:19], s68 offen offset:0 sc1
  buffer_load_dwordx4 v[96:99], v120, s[16:19], s68 offen offset:1024 sc1
  buffer_load_dwordx4 v[100:103], v120, s[16:19], s68 offen offset:2048 sc1
  buffer_load_dwordx4 v[104:107], v120, s[16:19], s68 offen offset:3072 sc1
  buffer_load_dwordx4 v[108:111], v120, s[16:19], s69 offen offset:0 sc1
  buffer_load_dwordx4 v[112:115], v120, s[16:19], s69 offen offset:1024 sc1
  buffer_load_dwordx4 v[116:119], v120, s[16:19], s69 offen offset:2048 sc1
  s_waitcnt vmcnt(0)
  v_cmp_ne_u64 s[36:37], s[60:61], v[94:95]
  v_cmp_ne_u64 s[38:39], s[60:61], v[98:99]
  v_cmp_ne_u64 s[40:41], s[60:61], v[102:103]
  v_cmp_ne_u64 s[42:43], s[60:61], v[106:107]
  v_cmp_ne_u64 s[44:45], s[60:61], v[110:111]
  v_cmp_ne_u64 s[46:47], s[60:61], v[114:115]
  v_cmp_ne_u64 s[48:49], s[60:61], v[118:119]
  s_or_b64 s[36:37], s[36:37], s[38:39]
  s_or_b64 s[36:37], s[36:37], s[40:41]
  s_or_b64 s[36:37], s[36:37], s[42:43]
  s_or_b64 s[36:37], s[36:37], s[44:45]
  s_or_b64 s[36:37], s[36:37], s[46:47]
  s_or_b64 s[36:37], s[36:37], s[48:49]
  s_cmp_lg_u64 s[36:37], 0
  s_cbranch_scc0 P1_zok
  s_sub_u32 s62, s62, 1
  s_cmp_lg_u32 s62, 0
  s_cbranch_scc1 P1_zspin_l
  s_branch P1_zok
P1_aux:
  s_waitcnt lgkmcnt(0)
  s_mov_b32 s6, 0x280000
  s_mov_b32 s7, 0x00020000
  s_mov_b32 s18, 0x2000000
  s_mov_b32 s19, 0x00020000
  s_mov_b32 s22, 0x100
  s_mov_b32 s23, 0x00020000
  s_load_dwordx2 s[8:9], s[0:1], 56
  s_load_dwordx2 s[12:13], s[0:1], 16
  s_load_dwordx2 s[24:25], s[0:1], 40
  buffer_load_dwordx2 v[204:205], v240, s[20:23], 0 offen sc1
  buffer_load_dword v212, v234, s[4:7], s41 offen offset:0
  buffer_load_dword v213, v234, s[4:7], s41 offen offset:256
  buffer_load_dword v214, v234, s[4:7], s41 offen offset:512
  buffer_load_dword v215, v234, s[4:7], s41 offen offset:768
  buffer_load_dword v216, v234, s[4:7], s41 offen offset:1024
  v_and_b32 v1, 63, v0
  s_and_b32 s33, s2, 6
  s_lshl_b32 s33, s33, 2
  s_bfe_u32 s34, s2, 0x30003
  s_add_u32 s33, s33, s34
  s_lshl_b32 s33, s33, 3
  s_and_b32 s34, s2, 1
  s_lshl_b32 s34, s34, 2
  s_add_u32 s33, s33, s34
  s_lshr_b32 s34, s2, 6
  s_add_u32 s33, s33, s34
  s_lshl_b32 s33, s33, 3
  s_add_u32 s33, s33, s28
  s_lshl_b32 s33, s33, 12
  s_add_u32 s64, s64, s33
  s_addc_u32 s65, s65, 0
  v_lshlrev_b32 v16, 6, v1
  global_load_dword v211, v16, s[64:65]
  s_waitcnt vmcnt(0)
  v_and_b32 v217, 0xffff0000, v212
  v_lshlrev_b32 v212, 16, v212
  v_and_b32 v218, 0xffff0000, v213
  v_lshlrev_b32 v213, 16, v213
  v_and_b32 v219, 0xffff0000, v214
  v_lshlrev_b32 v214, 16, v214
  v_and_b32 v220, 0xffff0000, v215
  v_lshlrev_b32 v215, 16, v215
  v_and_b32 v221, 0xffff0000, v216
  v_lshlrev_b32 v216, 16, v216
  v_add_f32 v222, v212, v213
  v_add_f32 v223, v214, v215
  v_add_f32 v222, v222, v216
  v_add_f32 v223, v223, v217
  v_add_f32 v222, v222, v218
  v_add_f32 v223, v223, v219
  v_add_f32 v222, v222, v220
  v_add_f32 v223, v223, v221
  v_add_f32 v222, v222, v223
  s_nop 1
  v_add_f32_dpp v222, v222, v222 quad_perm:[1,0,3,2] row_mask:0xf bank_mask:0xf
  s_nop 1
  v_add_f32_dpp v222, v222, v222 quad_perm:[2,3,0,1] row_mask:0xf bank_mask:0xf
  s_nop 1
  v_add_f32_dpp v222, v222, v222 row_half_mirror row_mask:0xf bank_mask:0xf
  s_nop 1
  v_add_f32_dpp v222, v222, v222 row_mirror row_mask:0xf bank_mask:0xf
  v_mov_b32 v223, v222
  s_nop 1
  v_permlane16_swap_b32 v222, v223
  v_add_f32 v222, v222, v223
  v_mov_b32 v223, v222
  s_nop 1
  v_permlane32_swap_b32 v222, v223
  v_add_f32 v222, v222, v223
  v_mul_f32 v222, 0x3acccccd, v222
  v_sub_f32 v212, v212, v222
  v_sub_f32 v213, v213, v222
  v_sub_f32 v214, v214, v222
  v_sub_f32 v215, v215, v222
  v_sub_f32 v216, v216, v222
  v_sub_f32 v217, v217, v222
  v_sub_f32 v218, v218, v222
  v_sub_f32 v219, v219, v222
  v_sub_f32 v220, v220, v222
  v_sub_f32 v221, v221, v222
  v_mul_f32 v241, v212, v212
  v_mul_f32 v223, v213, v213
  v_fmac_f32 v241, v214, v214
  v_fmac_f32 v223, v215, v215
  v_fmac_f32 v241, v216, v216
  v_fmac_f32 v223, v217, v217
  v_fmac_f32 v241, v218, v218
  v_fmac_f32 v223, v219, v219
  v_fmac_f32 v241, v220, v220
  v_fmac_f32 v223, v221, v221
  v_add_f32 v241, v241, v223
  s_nop 1
  v_add_f32_dpp v241, v241, v241 quad_perm:[1,0,3,2] row_mask:0xf bank_mask:0xf
  s_nop 1
  v_add_f32_dpp v241, v241, v241 quad_perm:[2,3,0,1] row_mask:0xf bank_mask:0xf
  s_nop 1
  v_add_f32_dpp v241, v241, v241 row_half_mirror row_mask:0xf bank_mask:0xf
  s_nop 1
  v_add_f32_dpp v241, v241, v241 row_mirror row_mask:0xf bank_mask:0xf
  v_mov_b32 v223, v241
  s_nop 1
  v_permlane16_swap_b32 v241, v223
  v_add_f32 v241, v241, v223
  v_mov_b32 v223, v241
  s_nop 1
  v_permlane32_swap_b32 v241, v223
  v_add_f32 v241, v241, v223
  v_mov_b32 v223, 0x3727c5ac
  v_fmac_f32 v223, 0x3acccccd, v241
  v_rsq_f32 v244, v223
  v_sub_f32 v245, 0, v222
  s_cmp_lg_u32 s28, 0
  s_cbranch_scc1 P1_aux_w
  s_mov_b32 s62, 200000
P1_aux_l:
  v_readfirstlane_b32 s60, v204
  v_readfirstlane_b32 s61, v205
  s_nop 2
  s_cmp_lg_u32 s60, 0
  s_cbranch_scc1 P1_aux_ok
  buffer_load_dwordx2 v[204:205], v240, s[20:23], 0 offen sc1
  s_waitcnt vmcnt(0)
  s_sub_u32 s62, s62, 1
  s_cmp_lg_u32 s62, 0
  s_cbranch_scc1 P1_aux_l
P1_aux_ok:
  v_mov_b32 v204, s60
  v_mov_b32 v205, s61
  v_mov_b32 v16, 132096
  ds_write_b64 v16, v[204:205]
P1_aux_w:
  s_waitcnt lgkmcnt(0)
  s_barrier
  v_mov_b32 v16, 132096
  ds_read_b64 v[246:247], v16
  s_waitcnt lgkmcnt(0)
  buffer_store_dwordx4 v[244:247], v15, s[16:19], s44 offen sc1
  s_mov_b32 s10, 0x10e000
  s_mov_b32 s11, 0x00020000
  s_mov_b32 s14, 0xc8000
  s_mov_b32 s15, 0x00020000
  v_and_b32 v1, 63, v0
  s_mov_b32 s36, 429496730
  v_add_u32 v100, 0, v1
  v_mul_hi_u32 v103, v100, s36
  v_mul_u32_u24 v101, 10, v103
  v_sub_u32 v102, v100, v101
  v_lshlrev_b32 v102, 4, v102
  v_and_b32 v101, 0xfffffff3, v103
  v_lshrrev_b32 v100, 1, v103
  v_and_b32 v100, 4, v100
  v_or_b32 v101, v101, v100
  v_lshlrev_b32 v100, 1, v103
  v_and_b32 v100, 8, v100
  v_or_b32 v101, v101, v100
  v_mul_u32_u24 v101, 1280, v101
  v_add_u32 v92, v101, v102
  v_add_u32 v100, 64, v1
  v_mul_hi_u32 v103, v100, s36
  v_mul_u32_u24 v101, 10, v103
  v_sub_u32 v102, v100, v101
  v_lshlrev_b32 v102, 4, v102
  v_and_b32 v101, 0xfffffff3, v103
  v_lshrrev_b32 v100, 1, v103
  v_and_b32 v100, 4, v100
  v_or_b32 v101, v101, v100
  v_lshlrev_b32 v100, 1, v103
  v_and_b32 v100, 8, v100
  v_or_b32 v101, v101, v100
  v_mul_u32_u24 v101, 1280, v101
  v_add_u32 v93, v101, v102
  v_add_u32 v100, 128, v1
  v_mul_hi_u32 v103, v100, s36
  v_mul_u32_u24 v101, 10, v103
  v_sub_u32 v102, v100, v101
  v_lshlrev_b32 v102, 4, v102
  v_and_b32 v101, 0xfffffff3, v103
  v_lshrrev_b32 v100, 1, v103
  v_and_b32 v100, 4, v100
  v_or_b32 v101, v101, v100
  v_lshlrev_b32 v100, 1, v103
  v_and_b32 v100, 8, v100
  v_or_b32 v101, v101, v100
  v_mul_u32_u24 v101, 1280, v101
  v_add_u32 v94, v101, v102
  v_add_u32 v100, 192, v1
  v_mul_hi_u32 v103, v100, s36
  v_mul_u32_u24 v101, 10, v103
  v_sub_u32 v102, v100, v101
  v_lshlrev_b32 v102, 4, v102
  v_and_b32 v101, 0xfffffff3, v103
  v_lshrrev_b32 v100, 1, v103
  v_and_b32 v100, 4, v100
  v_or_b32 v101, v101, v100
  v_lshlrev_b32 v100, 1, v103
  v_and_b32 v100, 8, v100
  v_or_b32 v101, v101, v100
  v_mul_u32_u24 v101, 1280, v101
  v_add_u32 v95, v101, v102
  v_add_u32 v100, 256, v1
  v_mul_hi_u32 v103, v100, s36
  v_mul_u32_u24 v101, 10, v103
  v_sub_u32 v102, v100, v101
  v_lshlrev_b32 v102, 4, v102
  v_and_b32 v101, 0xfffffff3, v103
  v_lshrrev_b32 v100, 1, v103
  v_and_b32 v100, 4, v100
  v_or_b32 v101, v101, v100
  v_lshlrev_b32 v100, 1, v103
  v_and_b32 v100, 8, v100
  v_or_b32 v101, v101, v100
  v_mul_u32_u24 v101, 1280, v101
  v_add_u32 v96, v101, v102
  s_mul_i32 s41, s28, 5120
  v_lshrrev_b32 v101, 5, v1
  v_lshlrev_b32 v101, 4, v101
  v_lshrrev_b32 v102, 4, v1
  v_and_b32 v102, 1, v102
  v_lshlrev_b32 v102, 2, v102
  v_add_u32 v101, v101, v102
  v_lshrrev_b32 v102, 2, v1
  v_and_b32 v102, 3, v102
  v_add_u32 v101, v101, v102
  v_mul_u32_u24 v101, 160, v101
  v_and_b32 v102, 3, v1
  v_lshlrev_b32 v102, 3, v102
  v_add_u32 v101, v101, v102
  v_add_u32 v97, s41, v101
  v_lshlrev_b32 v98, 4, v1
  s_lshl_b32 s37, s29, 3
  s_add_u32 s37, s37, s28
P1_rp:
  s_cmp_ge_u32 s37, 376
  s_cbranch_scc1 P1_rpd
  s_mov_b32 s36, 91382283
  s_mul_hi_u32 s38, s37, s36
  s_mul_i32 s39, s38, 47
  s_sub_u32 s39, s37, s39
  s_mul_i32 s38, s38, 160
  s_mul_i32 s42, s37, 5120
  s_add_u32 s42, s42, 25165824
  s_cmp_ge_u32 s39, 27
  s_cbranch_scc1 P1_rpq
  s_mul_i32 s40, s39, 40960
  s_add_u32 s40, s40, s38
  s_add_u32 m0, s41, 0
  s_nop 0
  buffer_load_dwordx4 v92, s[8:11], s40 offen lds
  s_add_u32 m0, s41, 1024
  s_nop 0
  buffer_load_dwordx4 v93, s[8:11], s40 offen lds
  s_add_u32 m0, s41, 2048
  s_nop 0
  buffer_load_dwordx4 v94, s[8:11], s40 offen lds
  s_add_u32 m0, s41, 3072
  s_nop 0
  buffer_load_dwordx4 v95, s[8:11], s40 offen lds
  s_add_u32 m0, s41, 4096
  s_nop 0
  buffer_load_dwordx4 v96, s[8:11], s40 offen lds
  s_branch P1_rpl
P1_rpq:
  s_sub_u32 s39, s39, 27
  s_mul_i32 s40, s39, 40960
  s_add_u32 s40, s40, s38
  s_add_u32 m0, s41, 0
  s_nop 0
  buffer_load_dwordx4 v92, s[12:15], s40 offen lds
  s_add_u32 m0, s41, 1024
  s_nop 0
  buffer_load_dwordx4 v93, s[12:15], s40 offen lds
  s_add_u32 m0, s41, 2048
  s_nop 0
  buffer_load_dwordx4 v94, s[12:15], s40 offen lds
  s_add_u32 m0, s41, 3072
  s_nop 0
  buffer_load_dwordx4 v95, s[12:15], s40 offen lds
  s_add_u32 m0, s41, 4096
  s_nop 0
  buffer_load_dwordx4 v96, s[12:15], s40 offen lds
P1_rpl:
  s_waitcnt vmcnt(0)
  ds_read_b64_tr_b16 v[108:109], v97 offset:0
  ds_read_b64_tr_b16 v[110:111], v97 offset:1280
  ds_read_b64_tr_b16 v[112:113], v97 offset:32
  ds_read_b64_tr_b16 v[114:115], v97 offset:1312
  ds_read_b64_tr_b16 v[116:117], v97 offset:64
  ds_read_b64_tr_b16 v[118:119], v97 offset:1344
  ds_read_b64_tr_b16 v[120:121], v97 offset:96
  ds_read_b64_tr_b16 v[122:123], v97 offset:1376
  ds_read_b64_tr_b16 v[124:125], v97 offset:128
  ds_read_b64_tr_b16 v[126:127], v97 offset:1408
  s_waitcnt lgkmcnt(0)
  s_and_b32 s33, s38, 32
  s_cmp_eq_u32 s33, 0
  s_cselect_b32 s33, 0, 2
  s_lshl_b32 s33, s33, 10
  s_add_u32 s33, s33, s42
  buffer_store_dwordx4 v[108:111], v98, s[16:19], s33 offen sc1
  s_and_b32 s33, s38, 32
  s_cmp_eq_u32 s33, 0
  s_cselect_b32 s33, 1, 0
  s_lshl_b32 s33, s33, 10
  s_add_u32 s33, s33, s42
  buffer_store_dwordx4 v[112:115], v98, s[16:19], s33 offen sc1
  s_and_b32 s33, s38, 32
  s_cmp_eq_u32 s33, 0
  s_cselect_b32 s33, 3, 1
  s_lshl_b32 s33, s33, 10
  s_add_u32 s33, s33, s42
  buffer_store_dwordx4 v[116:119], v98, s[16:19], s33 offen sc1
  s_and_b32 s33, s38, 32
  s_cmp_eq_u32 s33, 0
  s_cselect_b32 s33, 4, 3
  s_lshl_b32 s33, s33, 10
  s_add_u32 s33, s33, s42
  buffer_store_dwordx4 v[120:123], v98, s[16:19], s33 offen sc1
  s_and_b32 s33, s38, 32
  s_cmp_eq_u32 s33, 0
  s_cselect_b32 s33, 2, 4
  s_lshl_b32 s33, s33, 10
  s_add_u32 s33, s33, s42
  buffer_store_dwordx4 v[124:127], v98, s[16:19], s33 offen sc1
  s_add_u32 s37, s37, 128
  s_branch P1_rp
P1_rpd:
P1_done:
p1x_kernel_end:
  s_endpgm
.section .rodata,"a"
.p2align 6
.amdhsa_kernel p1x_kernel
  .amdhsa_next_free_vgpr 256
  .amdhsa_next_free_sgpr 102
  .amdhsa_accum_offset 256
  .amdhsa_group_segment_fixed_size 0
  .amdhsa_kernarg_size 88
  .amdhsa_user_sgpr_count 2
  .amdhsa_user_sgpr_kernarg_segment_ptr 1
  .amdhsa_system_sgpr_workgroup_id_x 1
.end_amdhsa_kernel
.text
.globl k2_kernel
.p2align 8
.type k2_kernel,@function
k2_kernel:
  s_cmp_ge_u32 s2, 256
  s_cbranch_scc1 k2_kernel_end
  s_load_dwordx2 s[8:9], s[0:1], 80
  s_load_dwordx2 s[4:5], s[0:1], 40
  s_load_dwordx2 s[12:13], s[0:1], 48
  s_load_dwordx2 s[24:25], s[0:1], 72
  s_load_dwordx2 s[16:17], s[0:1], 0
  s_load_dwordx2 s[20:21], s[0:1], 64
  v_lshrrev_b32 v59, 6, v0
  s_nop 0
  v_readfirstlane_b32 s28, v59
  s_nop 3
  s_cmp_lg_u32 s28, 7
  s_cbranch_scc1 K2_noprio
  s_setprio 3
K2_noprio:
  s_and_b32 s33, s2, 7
  s_lshr_b32 s34, s2, 3
  s_lshr_b32 s29, s33, 1
  s_lshl_b32 s29, s29, 3
  s_and_b32 s30, s34, 7
  s_add_u32 s29, s29, s30
  s_and_b32 s30, s33, 1
  s_lshl_b32 s30, s30, 2
  s_lshr_b32 s34, s34, 3
  s_add_u32 s30, s30, s34
  s_lshl_b32 s30, s30, 2
  s_lshr_b32 s30, 0x75436210, s30
  s_and_b32 s30, s30, 7
  s_mul_i32 s31, s30, 7
  s_mul_i32 s33, s30, 6
  s_add_u32 s33, s33, 6
  s_min_u32 s31, s31, s33
  s_cmp_lt_u32 s30, 6
  s_cselect_b32 s32, 7, 6
  s_and_b32 s42, s28, 3
  s_lshr_b32 s41, s28, 2
  s_lshr_b32 s60, s28, 1
  s_and_b32 s61, s28, 1
  v_and_b32 v43, 7, v0
  v_lshlrev_b32 v43, 4, v43
  v_bfe_u32 v42, v0, 3, 3
  v_lshrrev_b32 v44, 1, v42
  v_mul_u32_u24 v44, 16128, v44
  v_lshl_add_u32 v44, v42, 7, v44
  v_add_u32 v44, 128, v44
  v_add_u32 v45, v44, v43
  v_subrev_u32 v34, 2, v42
  v_and_b32 v34, 7, v34
  v_mul_u32_u24 v44, 86, v34
  v_lshrrev_b32 v44, 8, v44
  v_mul_u32_u24 v44, 16000, v44
  v_lshl_add_u32 v44, v34, 7, v44
  v_add_u32 v44, 0x280000, v44
  v_add_u32 v46, v44, v43
  v_lshlrev_b32 v44, 7, v42
  v_add_u32 v44, 65664, v44
  v_add_u32 v44, v44, v43
  v_cmp_gt_u32 vcc, 2, v42
  s_nop 1
  v_cndmask_b32 v46, v46, v44, vcc
  v_add_u32 v34, 6, v42
  v_mul_u32_u24 v44, 86, v34
  v_lshrrev_b32 v44, 8, v44
  v_mul_u32_u24 v44, 16000, v44
  v_lshl_add_u32 v44, v34, 7, v44
  v_add_u32 v44, 0x280000, v44
  v_add_u32 v47, v44, v43
  v_subrev_u32 v34, 1, v42
  v_and_b32 v34, 7, v34
  v_mul_u32_u24 v44, 86, v34
  v_lshrrev_b32 v44, 8, v44
  v_mul_u32_u24 v44, 16000, v44
  v_lshl_add_u32 v44, v34, 7, v44
  v_add_u32 v44, 0x500000, v44
  v_add_u32 v48, v44, v43
  v_add_u32 v44, 0x290100, v43
  v_cmp_eq_u32 vcc, 0, v42
  s_nop 1
  v_cndmask_b32 v48, v48, v44, vcc
  v_add_u32 v34, 7, v42
  v_mul_u32_u24 v44, 86, v34
  v_lshrrev_b32 v44, 8, v44
  v_mul_u32_u24 v44, 16000, v44
  v_lshl_add_u32 v44, v34, 7, v44
  v_add_u32 v44, 0x500000, v44
  v_add_u32 v49, v44, v43
  s_mul_i32 s56, s30, 20
  s_mul_i32 s33, s60, 5
  s_add_u32 s56, s56, s33
  s_lshl_b32 s56, s56, 14
  s_lshl_b32 s33, s29, 9
  s_add_u32 s56, s56, s33
  s_lshl_b32 s33, s61, 8
  s_add_u32 s56, s56, s33
  s_add_u32 s56, s56, 16777088
  s_mul_i32 s57, s28, 5120
  s_add_u32 s57, s57, 81920
  s_waitcnt lgkmcnt(0)
  s_mov_b32 s10, 0x2000000
  s_mov_b32 s11, 0x00020000
  s_mov_b32 s18, 0x280000
  s_mov_b32 s19, 0x00020000
  s_mov_b32 s22, 0x280000
  s_mov_b32 s23, 0x00020000
  s_mov_b32 s26, 0x100
  s_mov_b32 s27, 0x00020000
  s_mov_b32 s14, 0x1000
  s_mov_b32 s15, 0x00020000
  s_add_u32 m0, s57, 0
  s_nop 0
  buffer_load_dwordx4 v45, s[8:11], s56 offen lds
  s_add_u32 m0, s57, 1024
  s_nop 0
  buffer_load_dwordx4 v46, s[8:11], s56 offen lds
  s_add_u32 m0, s57, 2048
  s_nop 0
  buffer_load_dwordx4 v47, s[8:11], s56 offen lds
  s_add_u32 m0, s57, 3072
  s_nop 0
  buffer_load_dwordx4 v48, s[8:11], s56 offen lds
  s_add_u32 m0, s57, 4096
  s_nop 0
  buffer_load_dwordx4 v49, s[8:11], s56 offen lds
  s_mov_b32 s55, 14221312
  s_load_dwordx2 s[52:53], s[8:9], s55
  s_lshl_b32 s54, s29, 6
  s_add_u32 s54, s54, 14155776
  s_cmp_ge_u32 s28, s32
  s_cbranch_scc1 K2_helper
  v_and_b32 v59, 63, v0
  v_and_b32 v57, 15, v59
  v_lshrrev_b32 v58, 4, v59
  s_add_u32 s31, s31, s28
  s_lshl_b32 s33, s31, 10
  v_lshlrev_b32 v59, 4, v59
  v_add_u32 v61, s33, v59
  s_mov_b32 s35, 0
  s_mov_b32 s36, 55296
  buffer_load_dwordx4 v[180:183], v61, s[8:11], s35 offen
  s_add_u32 s35, s35, 110592
  buffer_load_dwordx4 v[184:187], v61, s[8:11], s36 offen
  s_add_u32 s36, s36, 110592
  buffer_load_dwordx4 v[188:191], v61, s[8:11], s35 offen
  s_add_u32 s35, s35, 110592
  buffer_load_dwordx4 v[192:195], v61, s[8:11], s36 offen
  s_add_u32 s36, s36, 110592
  v_lshrrev_b32 v60, 1, v57
  v_xor_b32 v59, v58, v60
  v_lshlrev_b32 v59, 4, v59
  v_lshlrev_b32 v60, 7, v57
  v_add_u32 v62, v59, v60
  v_xor_b32 v64, 64, v62
  v_add_u32 v63, 0x10000, v62
  v_add_u32 v65, 0x10000, v64
  s_mov_b32 s37, 0xc0135761
  v_mov_b32 v66, 0xbdd2d3e8
  s_mov_b32 s38, 27648
  s_mov_b32 s39, 55296
  s_mov_b32 s40, 82944
  s_lshl_b32 s33, s29, 2
  s_mul_i32 s34, s33, 54
  s_add_u32 s34, s34, s31
  s_lshl_b32 s34, s34, 9
  v_and_b32 v59, 1, v58
  v_lshlrev_b32 v59, 8, v59
  v_lshlrev_b32 v60, 4, v57
  v_add_u32 v59, v59, v60
  v_lshrrev_b32 v60, 1, v58
  v_mul_u32_u24 v60, 27648, v60
  v_add_u32 v59, v59, v60
  v_add_u32 v99, s34, v59
  v_add_u32 v99, 3670016, v99
  v_lshrrev_b32 v59, 1, v58
  v_lshlrev_b32 v59, 8, v59
  v_lshlrev_b32 v60, 4, v57
  v_add_u32 v59, v59, v60
  v_and_b32 v60, 1, v58
  v_lshlrev_b32 v60, 3, v60
  v_add_u32 v59, v59, v60
  v_add_u32 v98, s34, v59
  v_add_u32 v98, 7340032, v98
  s_lshl_b32 s33, s33, 5
  v_and_b32 v59, 63, v0
  v_lshlrev_b32 v59, 1, v59
  v_add_u32 v58, s33, v59
  v_and_b32 v45, 63, v0
  v_and_b32 v46, 15, v45
  v_lshrrev_b32 v47, 4, v45
  v_lshlrev_b32 v43, 4, v46
  v_lshl_add_u32 v42, v47, 8, v43
  v_add_u32 v34, s57, v42
  s_add_u32 s33, s57, 1152
  v_mul_u32_u24 v42, 384, v47
  v_add_u32 v42, v42, v43
  v_add_u32 v35, s33, v42
  s_add_u32 s33, s33, 1536
  v_add_u32 v36, s33, v43
  s_add_u32 s33, s57, 3072
  v_and_b32 v42, 3, v45
  v_mul_u32_u24 v42, 384, v42
  v_lshrrev_b32 v43, 2, v45
  v_lshl_add_u32 v42, v43, 4, v42
  v_add_u32 v37, s33, v42
  s_mul_i32 s33, s60, 5
  v_add_u32 v42, s33, v47
  v_lshrrev_b32 v43, 1, v42
  v_lshlrev_b32 v43, 10, v43
  v_and_b32 v42, 1, v42
  v_lshl_add_u32 v42, v42, 3, v43
  v_lshlrev_b32 v43, 5, v46
  v_add_u32 v42, v42, v43
  s_lshl_b32 s34, s61, 9
  s_add_u32 s34, s34, 122880
  v_add_u32 v38, s34, v42
  s_add_u32 s33, s33, 4
  s_and_b32 s48, s33, 1
  s_lshl_b32 s48, s48, 3
  s_lshr_b32 s33, s33, 1
  s_lshl_b32 s33, s33, 10
  s_add_u32 s33, s33, s48
  s_add_u32 s33, s33, s34
  v_add_u32 v39, s33, v43
  v_lshlrev_b32 v42, 2, v47
  v_sub_u32 v42, v42, v46
  s_or_b32 s33, s29, s61
  s_cmp_eq_u32 s33, 0
  s_cselect_b32 s33, 100, 9
  v_mov_b32 v44, 0xff61b1e6
  v_add_u32 v43, 0, v42
  v_cmp_gt_i32 vcc, s33, v43
  s_nop 1
  v_cndmask_b32 v20, 0, v44, vcc
  v_add_u32 v43, 7, v43
  v_cmp_lt_u32 vcc, 7, v43
  s_nop 1
  v_cndmask_b32 v24, 0, v44, vcc
  v_add_u32 v43, 1, v42
  v_cmp_gt_i32 vcc, s33, v43
  s_nop 1
  v_cndmask_b32 v21, 0, v44, vcc
  v_add_u32 v43, 7, v43
  v_cmp_lt_u32 vcc, 7, v43
  s_nop 1
  v_cndmask_b32 v25, 0, v44, vcc
  v_add_u32 v43, 2, v42
  v_cmp_gt_i32 vcc, s33, v43
  s_nop 1
  v_cndmask_b32 v22, 0, v44, vcc
  v_add_u32 v43, 7, v43
  v_cmp_lt_u32 vcc, 7, v43
  s_nop 1
  v_cndmask_b32 v26, 0, v44, vcc
  v_add_u32 v43, 3, v42
  v_cmp_gt_i32 vcc, s33, v43
  s_nop 1
  v_cndmask_b32 v23, 0, v44, vcc
  v_add_u32 v43, 7, v43
  v_cmp_lt_u32 vcc, 7, v43
  s_nop 1
  v_cndmask_b32 v27, 0, v44, vcc
  v_mov_b32 v102, 0
  v_mov_b32 v103, 0
  v_mov_b32 v142, 0
  v_mov_b32 v143, 0
  v_mul_u32_u24 v42, 20480, v47
  v_lshl_add_u32 v40, v46, 4, v42
  v_lshlrev_b32 v41, 4, v0
  v_add_u32 v41, 122880, v41
  s_mul_i32 s34, s29, 81920
  s_add_u32 s34, s34, 11010048
  s_mul_i32 s33, s30, 10
  s_add_u32 s33, s33, s28
  s_and_b32 s58, s33, 3
  s_lshl_b32 s58, s58, 8
  s_lshr_b32 s33, s33, 2
  s_lshl_b32 s33, s33, 10
  s_add_u32 s58, s58, s33
  s_add_u32 s58, s58, s34
  s_mul_i32 s33, s30, 10
  s_add_u32 s33, s33, s28
  s_add_u32 s33, s33, 8
  s_and_b32 s59, s33, 3
  s_lshl_b32 s59, s59, 8
  s_lshr_b32 s33, s33, 2
  s_lshl_b32 s33, s33, 10
  s_add_u32 s59, s59, s33
  s_add_u32 s59, s59, s34
  s_cmp_lt_u32 s28, 2
  s_cselect_b32 s59, s59, 0x80000000
  s_mov_b32 s62, 0x3ea52b5c
  s_waitcnt vmcnt(4) lgkmcnt(0)
  v_mov_b32 v52, s52
  v_mov_b32 v53, s53
  ds_read_b64 v[100:101], v34 offset:0
  ds_read_b64 v[104:105], v35 offset:0
  ds_read_b64 v[106:107], v36 offset:0
  ds_read_b64 v[108:109], v35 offset:256
  ds_read_b64 v[110:111], v36 offset:256
  s_mov_b64 exec, 0xffff
  ds_read_b64 v[102:103], v34 offset:1024
  s_mov_b64 exec, -1
  ds_read_b64 v[140:141], v34 offset:8
  ds_read_b64 v[144:145], v35 offset:8
  ds_read_b64 v[146:147], v36 offset:8
  ds_read_b64 v[148:149], v35 offset:264
  ds_read_b64 v[150:151], v36 offset:264
  s_mov_b64 exec, 0xffff
  ds_read_b64 v[142:143], v34 offset:1032
  s_mov_b64 exec, -1
  ds_read_b64_tr_b16 v[112:113], v37 offset:0
  ds_read_b64_tr_b16 v[114:115], v37 offset:256
  ds_read_b64_tr_b16 v[116:117], v37 offset:1536
  ds_read_b64_tr_b16 v[118:119], v37 offset:1792
  ds_read_b64_tr_b16 v[152:153], v37 offset:8
  ds_read_b64_tr_b16 v[154:155], v37 offset:264
  ds_read_b64_tr_b16 v[156:157], v37 offset:1544
  ds_read_b64_tr_b16 v[158:159], v37 offset:1800
  s_waitcnt lgkmcnt(14)
  v_mfma_f32_16x16x32_bf16 v[120:123], v[104:107], v[100:103], v[20:23]
  v_mfma_f32_16x16x32_bf16 v[124:127], v[108:111], v[100:103], v[24:27]
  s_waitcnt lgkmcnt(8)
  v_mfma_f32_16x16x32_bf16 v[160:163], v[144:147], v[140:143], v[20:23]
  v_mfma_f32_16x16x32_bf16 v[164:167], v[148:151], v[140:143], v[24:27]
  s_nop 3
  v_max3_f32 v28, v120, v121, v122
  buffer_load_dwordx4 v[196:199], v61, s[8:11], s35 offen
  s_add_u32 s35, s35, 110592
  v_max3_f32 v28, v28, v123, v124
  v_max3_f32 v28, v28, v125, v126
  v_max_f32 v28, v28, v127
  v_max3_f32 v31, v160, v161, v162
  v_max3_f32 v31, v31, v163, v164
  v_max3_f32 v31, v31, v165, v166
  v_max_f32 v31, v31, v167
  v_mov_b32 v29, v28
  v_mov_b32 v32, v31
  s_nop 0
  v_permlane16_swap_b32 v28, v29
  v_permlane16_swap_b32 v31, v32
  v_max_f32 v28, v28, v29
  v_max_f32 v31, v31, v32
  v_mov_b32 v29, v28
  v_mov_b32 v32, v31
  s_nop 0
  v_permlane32_swap_b32 v28, v29
  v_permlane32_swap_b32 v31, v32
  v_max_f32 v28, v28, v29
  v_max_f32 v31, v31, v32
  v_mul_f32 v28, s62, v28
  v_mul_f32 v31, s62, v31
  v_fma_f32 v120, v120, s62, -v28
  v_fma_f32 v160, v160, s62, -v31
  v_fma_f32 v121, v121, s62, -v28
  v_fma_f32 v161, v161, s62, -v31
  buffer_load_dwordx4 v[200:203], v61, s[8:11], s36 offen
  s_add_u32 s36, s36, 110592
  v_fma_f32 v122, v122, s62, -v28
  v_fma_f32 v162, v162, s62, -v31
  v_fma_f32 v123, v123, s62, -v28
  v_fma_f32 v163, v163, s62, -v31
  v_fma_f32 v124, v124, s62, -v28
  v_fma_f32 v164, v164, s62, -v31
  v_fma_f32 v125, v125, s62, -v28
  v_fma_f32 v165, v165, s62, -v31
  v_fma_f32 v126, v126, s62, -v28
  v_fma_f32 v166, v166, s62, -v31
  v_fma_f32 v127, v127, s62, -v28
  v_fma_f32 v167, v167, s62, -v31
  v_exp_f32 v120, v120
  v_exp_f32 v160, v160
  v_exp_f32 v121, v121
  v_exp_f32 v161, v161
  v_exp_f32 v122, v122
  v_exp_f32 v162, v162
  v_exp_f32 v123, v123
  v_exp_f32 v163, v163
  v_exp_f32 v124, v124
  v_exp_f32 v164, v164
  v_exp_f32 v125, v125
  v_exp_f32 v165, v165
  v_exp_f32 v126, v126
  buffer_load_dwordx4 v[204:207], v61, s[8:11], s35 offen
  s_add_u32 s35, s35, 110592
  v_exp_f32 v166, v166
  v_exp_f32 v127, v127
  v_exp_f32 v167, v167
  v_cvt_pk_bf16_f32 v128, v120, v121
  v_cvt_pk_bf16_f32 v129, v122, v123
  v_cvt_pk_bf16_f32 v130, v124, v125
  v_cvt_pk_bf16_f32 v131, v126, v127
  v_cvt_pk_bf16_f32 v168, v160, v161
  v_cvt_pk_bf16_f32 v169, v162, v163
  v_cvt_pk_bf16_f32 v170, v164, v165
  v_cvt_pk_bf16_f32 v171, v166, v167
  v_add_f32 v30, v120, v121
  v_add_f32 v30, v30, v122
  v_add_f32 v30, v30, v123
  v_add_f32 v30, v30, v124
  v_add_f32 v30, v30, v125
  v_add_f32 v30, v30, v126
  v_add_f32 v30, v30, v127
  v_add_f32 v33, v160, v161
  v_add_f32 v33, v33, v162
  v_add_f32 v33, v33, v163
  v_add_f32 v33, v33, v164
  v_add_f32 v33, v33, v165
  v_add_f32 v33, v33, v166
  v_add_f32 v33, v33, v167
  buffer_load_dwordx4 v[208:211], v61, s[8:11], s36 offen
  s_add_u32 s36, s36, 110592
  s_waitcnt lgkmcnt(0)
  v_mfma_f32_16x16x32_bf16 v[132:135], v[112:115], v[128:131], 0
  v_mfma_f32_16x16x32_bf16 v[136:139], v[116:119], v[128:131], 0
  v_mfma_f32_16x16x32_bf16 v[172:175], v[152:155], v[168:171], 0
  v_mfma_f32_16x16x32_bf16 v[176:179], v[156:159], v[168:171], 0
  v_mov_b32 v29, v30
  v_mov_b32 v32, v33
  s_nop 0
  v_permlane16_swap_b32 v30, v29
  v_permlane16_swap_b32 v33, v32
  v_add_f32 v30, v30, v29
  v_add_f32 v33, v33, v32
  v_mov_b32 v29, v30
  v_mov_b32 v32, v33
  s_nop 0
  v_permlane32_swap_b32 v30, v29
  v_permlane32_swap_b32 v33, v32
  v_add_f32 v30, v30, v29
  v_add_f32 v33, v33, v32
  v_rcp_f32 v30, v30
  v_rcp_f32 v33, v33
  v_mul_f32 v132, v132, v30
  v_mul_f32 v133, v133, v30
  v_mul_f32 v134, v134, v30
  v_mul_f32 v135, v135, v30
  v_cvt_pk_bf16_f32 v132, v132, v133
  v_cvt_pk_bf16_f32 v133, v134, v135
  buffer_load_dwordx4 v[72:75], v99, s[8:11], 0 offen
  v_mul_f32 v136, v136, v30
  v_mul_f32 v137, v137, v30
  v_mul_f32 v138, v138, v30
  v_mul_f32 v139, v139, v30
  v_cvt_pk_bf16_f32 v136, v136, v137
  v_cvt_pk_bf16_f32 v137, v138, v139
  v_mul_f32 v172, v172, v33
  v_mul_f32 v173, v173, v33
  v_mul_f32 v174, v174, v33
  v_mul_f32 v175, v175, v33
  v_cvt_pk_bf16_f32 v172, v172, v173
  v_cvt_pk_bf16_f32 v173, v174, v175
  v_mul_f32 v176, v176, v33
  v_mul_f32 v177, v177, v33
  v_mul_f32 v178, v178, v33
  v_mul_f32 v179, v179, v33
  v_cvt_pk_bf16_f32 v176, v176, v177
  v_cvt_pk_bf16_f32 v177, v178, v179
  ds_write_b64 v38, v[132:133] offset:0
  ds_write_b64 v38, v[172:173] offset:16
  s_mov_b64 exec, 0xffff
  ds_write_b64 v39, v[136:137] offset:0
  ds_write_b64 v39, v[176:177] offset:16
  s_mov_b64 exec, -1
  buffer_load_dwordx4 v[76:79], v99, s[8:11], s39 offen
  buffer_load_dwordx4 v[212:215], v61, s[8:11], s35 offen
  s_add_u32 s35, s35, 110592
  buffer_load_dwordx4 v[216:219], v61, s[8:11], s36 offen
  s_add_u32 s36, s36, 110592
  buffer_load_dwordx4 v[220:223], v61, s[8:11], s35 offen
  s_add_u32 s35, s35, 110592
  buffer_load_dwordx4 v[224:227], v61, s[8:11], s36 offen
  s_add_u32 s36, s36, 110592
  buffer_load_dwordx4 v[228:231], v61, s[8:11], s35 offen
  s_add_u32 s35, s35, 110592
  buffer_load_dwordx4 v[232:235], v61, s[8:11], s36 offen
  s_add_u32 s36, s36, 110592
  buffer_load_ushort v68, v58, s[12:15], 0 offen
  s_waitcnt lgkmcnt(0)
  s_barrier
  ds_read_b128 v[20:23], v41
  ds_read_b128 v[24:27], v41 offset:8192
  ds_read_b128 v[116:119], v62 offset:0
  ds_read_b128 v[120:123], v62 offset:2048
  ds_read_b128 v[124:127], v62 offset:4096
  ds_read_b128 v[128:131], v62 offset:6144
  ds_read_b128 v[132:135], v64 offset:0
  ds_read_b128 v[136:139], v64 offset:2048
  ds_read_b128 v[140:143], v64 offset:4096
  ds_read_b128 v[144:147], v64 offset:6144
  s_waitcnt lgkmcnt(8)
  buffer_store_dwordx4 v[20:23], v40, s[8:11], s58 offen sc1
  buffer_store_dwordx4 v[24:27], v40, s[8:11], s59 offen sc1
  buffer_load_dwordx4 v[236:239], v61, s[8:11], s35 offen
  s_add_u32 s35, s35, 110592
  buffer_load_dwordx4 v[240:243], v61, s[8:11], s36 offen
  s_add_u32 s36, s36, 110592
  ds_read_b128 v[148:151], v62 offset:8192
  ds_read_b128 v[152:155], v62 offset:10240
  ds_read_b128 v[156:159], v62 offset:12288
  ds_read_b128 v[160:163], v62 offset:14336
  ds_read_b128 v[164:167], v64 offset:8192
  ds_read_b128 v[168:171], v64 offset:10240
  ds_read_b128 v[172:175], v64 offset:12288
  ds_read_b128 v[176:179], v64 offset:14336
  s_waitcnt vmcnt(19) lgkmcnt(8)
  buffer_load_dwordx4 v[244:247], v61, s[8:11], s35 offen
  s_add_u32 s35, s35, 110592
  v_mfma_f32_16x16x32_bf16 v[100:103], v[180:183], v[116:119], 0
  v_mfma_f32_16x16x32_bf16 v[104:107], v[180:183], v[120:123], 0
  v_mfma_f32_16x16x32_bf16 v[108:111], v[180:183], v[124:127], 0
  v_mfma_f32_16x16x32_bf16 v[112:115], v[180:183], v[128:131], 0
  buffer_load_dwordx4 v[248:251], v61, s[8:11], s36 offen
  s_add_u32 s36, s36, 110592
  v_mfma_f32_16x16x32_bf16 v[100:103], v[184:187], v[132:135], v[100:103]
  v_mfma_f32_16x16x32_bf16 v[104:107], v[184:187], v[136:139], v[104:107]
  v_mfma_f32_16x16x32_bf16 v[108:111], v[184:187], v[140:143], v[108:111]
  v_mfma_f32_16x16x32_bf16 v[112:115], v[184:187], v[144:147], v[112:115]
  s_barrier
  ds_read_b128 v[116:119], v62 offset:16384
  ds_read_b128 v[120:123], v62 offset:18432
  ds_read_b128 v[124:127], v62 offset:20480
  ds_read_b128 v[128:131], v62 offset:22528
  ds_read_b128 v[132:135], v64 offset:16384
  ds_read_b128 v[136:139], v64 offset:18432
  ds_read_b128 v[140:143], v64 offset:20480
  ds_read_b128 v[144:147], v64 offset:22528
  s_waitcnt vmcnt(19) lgkmcnt(8)
  buffer_load_dwordx4 v[180:183], v61, s[8:11], s35 offen
  s_add_u32 s35, s35, 110592
  v_mfma_f32_16x16x32_bf16 v[100:103], v[188:191], v[148:151], v[100:103]
  v_mfma_f32_16x16x32_bf16 v[104:107], v[188:191], v[152:155], v[104:107]
  v_mfma_f32_16x16x32_bf16 v[108:111], v[188:191], v[156:159], v[108:111]
  v_mfma_f32_16x16x32_bf16 v[112:115], v[188:191], v[160:163], v[112:115]
  buffer_load_dwordx4 v[184:187], v61, s[8:11], s36 offen
  s_add_u32 s36, s36, 110592
  v_mfma_f32_16x16x32_bf16 v[100:103], v[192:195], v[164:167], v[100:103]
  v_mfma_f32_16x16x32_bf16 v[104:107], v[192:195], v[168:171], v[104:107]
  v_mfma_f32_16x16x32_bf16 v[108:111], v[192:195], v[172:175], v[108:111]
  v_mfma_f32_16x16x32_bf16 v[112:115], v[192:195], v[176:179], v[112:115]
  ds_read_b128 v[148:151], v62 offset:24576
  ds_read_b128 v[152:155], v62 offset:26624
  ds_read_b128 v[156:159], v62 offset:28672
  ds_read_b128 v[160:163], v62 offset:30720
  ds_read_b128 v[164:167], v64 offset:24576
  ds_read_b128 v[168:171], v64 offset:26624
  ds_read_b128 v[172:175], v64 offset:28672
  ds_read_b128 v[176:179], v64 offset:30720
  s_waitcnt vmcnt(15) lgkmcnt(8)
  buffer_load_dwordx4 v[188:191], v61, s[8:11], s35 offen
  s_add_u32 s35, s35, 110592
  v_mfma_f32_16x16x32_bf16 v[100:103], v[196:199], v[116:119], v[100:103]
  v_permlane32_swap_b32 v72, v74
  v_mfma_f32_16x16x32_bf16 v[104:107], v[196:199], v[120:123], v[104:107]
  v_permlane32_swap_b32 v73, v75
  v_mfma_f32_16x16x32_bf16 v[108:111], v[196:199], v[124:127], v[108:111]
  v_permlane32_swap_b32 v76, v78
  v_mfma_f32_16x16x32_bf16 v[112:115], v[196:199], v[128:131], v[112:115]
  v_permlane32_swap_b32 v77, v79
  buffer_load_dwordx4 v[192:195], v61, s[8:11], s36 offen
  s_add_u32 s36, s36, 110592
  v_mfma_f32_16x16x32_bf16 v[100:103], v[200:203], v[132:135], v[100:103]
  v_lshlrev_b32 v80, 16, v72
  v_mfma_f32_16x16x32_bf16 v[104:107], v[200:203], v[136:139], v[104:107]
  v_mul_f32 v96, v80, v80
  v_mfma_f32_16x16x32_bf16 v[108:111], v[200:203], v[140:143], v[108:111]
  v_fma_f32 v96, v96, v66, s37
  v_mfma_f32_16x16x32_bf16 v[112:115], v[200:203], v[144:147], v[112:115]
  v_mul_f32 v96, v80, v96
  v_exp_f32 v96, v96
  s_nop 0
  v_add_f32 v96, 1.0, v96
  v_rcp_f32 v96, v96
  s_nop 0
  v_mul_f32 v80, v80, v96
  s_barrier
  ds_read_b128 v[116:119], v62 offset:32768
  ds_read_b128 v[120:123], v62 offset:34816
  ds_read_b128 v[124:127], v62 offset:36864
  ds_read_b128 v[128:131], v62 offset:38912
  ds_read_b128 v[132:135], v64 offset:32768
  ds_read_b128 v[136:139], v64 offset:34816
  ds_read_b128 v[140:143], v64 offset:36864
  ds_read_b128 v[144:147], v64 offset:38912
  s_waitcnt vmcnt(19) lgkmcnt(8)
  buffer_load_dwordx4 v[196:199], v61, s[8:11], s35 offen
  s_add_u32 s35, s35, 110592
  v_mfma_f32_16x16x32_bf16 v[100:103], v[204:207], v[148:151], v[100:103]
  v_and_b32 v81, 0xffff0000, v72
  v_mfma_f32_16x16x32_bf16 v[104:107], v[204:207], v[152:155], v[104:107]
  v_mul_f32 v97, v81, v81
  v_mfma_f32_16x16x32_bf16 v[108:111], v[204:207], v[156:159], v[108:111]
  v_fma_f32 v97, v97, v66, s37
  v_mfma_f32_16x16x32_bf16 v[112:115], v[204:207], v[160:163], v[112:115]
  v_mul_f32 v97, v81, v97
  buffer_load_dwordx4 v[200:203], v61, s[8:11], s36 offen
  s_add_u32 s36, s36, 110592
  v_mfma_f32_16x16x32_bf16 v[100:103], v[208:211], v[164:167], v[100:103]
  v_exp_f32 v97, v97
  v_mfma_f32_16x16x32_bf16 v[104:107], v[208:211], v[168:171], v[104:107]
  v_add_f32 v97, 1.0, v97
  v_mfma_f32_16x16x32_bf16 v[108:111], v[208:211], v[172:175], v[108:111]
  v_rcp_f32 v97, v97
  v_mfma_f32_16x16x32_bf16 v[112:115], v[208:211], v[176:179], v[112:115]
  v_mul_f32 v81, v81, v97
  ds_read_b128 v[148:151], v62 offset:40960
  ds_read_b128 v[152:155], v62 offset:43008
  ds_read_b128 v[156:159], v62 offset:45056
  ds_read_b128 v[160:163], v62 offset:47104
  ds_read_b128 v[164:167], v64 offset:40960
  ds_read_b128 v[168:171], v64 offset:43008
  ds_read_b128 v[172:175], v64 offset:45056
  ds_read_b128 v[176:179], v64 offset:47104
  s_waitcnt vmcnt(17) lgkmcnt(8)
  buffer_load_dwordx4 v[204:207], v61, s[8:11], s35 offen
  s_add_u32 s35, s35, 110592
  v_mfma_f32_16x16x32_bf16 v[100:103], v[212:215], v[116:119], v[100:103]
  v_lshlrev_b32 v82, 16, v73
  v_mfma_f32_16x16x32_bf16 v[104:107], v[212:215], v[120:123], v[104:107]
  v_mul_f32 v96, v82, v82
  v_mfma_f32_16x16x32_bf16 v[108:111], v[212:215], v[124:127], v[108:111]
  v_fma_f32 v96, v96, v66, s37
  v_mfma_f32_16x16x32_bf16 v[112:115], v[212:215], v[128:131], v[112:115]
  v_mul_f32 v96, v82, v96
  buffer_load_dwordx4 v[208:211], v61, s[8:11], s36 offen
  s_add_u32 s36, s36, 110592
  v_mfma_f32_16x16x32_bf16 v[100:103], v[216:219], v[132:135], v[100:103]
  v_exp_f32 v96, v96
  v_mfma_f32_16x16x32_bf16 v[104:107], v[216:219], v[136:139], v[104:107]
  v_add_f32 v96, 1.0, v96
  v_mfma_f32_16x16x32_bf16 v[108:111], v[216:219], v[140:143], v[108:111]
  v_rcp_f32 v96, v96
  v_mfma_f32_16x16x32_bf16 v[112:115], v[216:219], v[144:147], v[112:115]
  v_mul_f32 v82, v82, v96
  s_barrier
  ds_read_b128 v[116:119], v62 offset:49152
  ds_read_b128 v[120:123], v62 offset:51200
  ds_read_b128 v[124:127], v62 offset:53248
  ds_read_b128 v[128:131], v62 offset:55296
  ds_read_b128 v[132:135], v64 offset:49152
  ds_read_b128 v[136:139], v64 offset:51200
  ds_read_b128 v[140:143], v64 offset:53248
  ds_read_b128 v[144:147], v64 offset:55296
  s_waitcnt vmcnt(17) lgkmcnt(8)
  buffer_load_dwordx4 v[212:215], v61, s[8:11], s35 offen
  s_add_u32 s35, s35, 110592
  v_mfma_f32_16x16x32_bf16 v[100:103], v[220:223], v[148:151], v[100:103]
  v_and_b32 v83, 0xffff0000, v73
  v_mfma_f32_16x16x32_bf16 v[104:107], v[220:223], v[152:155], v[104:107]
  v_mul_f32 v97, v83, v83
  v_mfma_f32_16x16x32_bf16 v[108:111], v[220:223], v[156:159], v[108:111]
  v_fma_f32 v97, v97, v66, s37
  v_mfma_f32_16x16x32_bf16 v[112:115], v[220:223], v[160:163], v[112:115]
  v_mul_f32 v97, v83, v97
  buffer_load_dwordx4 v[216:219], v61, s[8:11], s36 offen
  s_add_u32 s36, s36, 110592
  v_mfma_f32_16x16x32_bf16 v[100:103], v[224:227], v[164:167], v[100:103]
  v_exp_f32 v97, v97
  v_mfma_f32_16x16x32_bf16 v[104:107], v[224:227], v[168:171], v[104:107]
  v_add_f32 v97, 1.0, v97
  v_mfma_f32_16x16x32_bf16 v[108:111], v[224:227], v[172:175], v[108:111]
  v_rcp_f32 v97, v97
  v_mfma_f32_16x16x32_bf16 v[112:115], v[224:227], v[176:179], v[112:115]
  v_mul_f32 v83, v83, v97
  ds_read_b128 v[148:151], v62 offset:57344
  ds_read_b128 v[152:155], v62 offset:59392
  ds_read_b128 v[156:159], v62 offset:61440
  ds_read_b128 v[160:163], v62 offset:63488
  ds_read_b128 v[164:167], v64 offset:57344
  ds_read_b128 v[168:171], v64 offset:59392
  ds_read_b128 v[172:175], v64 offset:61440
  ds_read_b128 v[176:179], v64 offset:63488
  s_waitcnt vmcnt(17) lgkmcnt(8)
  buffer_load_dwordx4 v[220:223], v61, s[8:11], s35 offen
  s_add_u32 s35, s35, 110592
  v_mfma_f32_16x16x32_bf16 v[100:103], v[228:231], v[116:119], v[100:103]
  v_lshlrev_b32 v84, 16, v74
  v_mfma_f32_16x16x32_bf16 v[104:107], v[228:231], v[120:123], v[104:107]
  v_mul_f32 v96, v84, v84
  v_mfma_f32_16x16x32_bf16 v[108:111], v[228:231], v[124:127], v[108:111]
  v_fma_f32 v96, v96, v66, s37
  v_mfma_f32_16x16x32_bf16 v[112:115], v[228:231], v[128:131], v[112:115]
  v_mul_f32 v96, v84, v96
  buffer_load_dwordx4 v[224:227], v61, s[8:11], s36 offen
  s_add_u32 s36, s36, 110592
  v_mfma_f32_16x16x32_bf16 v[100:103], v[232:235], v[132:135], v[100:103]
  v_exp_f32 v96, v96
  v_mfma_f32_16x16x32_bf16 v[104:107], v[232:235], v[136:139], v[104:107]
  v_add_f32 v96, 1.0, v96
  v_mfma_f32_16x16x32_bf16 v[108:111], v[232:235], v[140:143], v[108:111]
  v_rcp_f32 v96, v96
  v_mfma_f32_16x16x32_bf16 v[112:115], v[232:235], v[144:147], v[112:115]
  v_mul_f32 v84, v84, v96
  s_barrier
  ds_read_b128 v[116:119], v63 offset:0
  ds_read_b128 v[120:123], v63 offset:2048
  ds_read_b128 v[124:127], v63 offset:4096
  ds_read_b128 v[128:131], v63 offset:6144
  ds_read_b128 v[132:135], v65 offset:0
  ds_read_b128 v[136:139], v65 offset:2048
  ds_read_b128 v[140:143], v65 offset:4096
  ds_read_b128 v[144:147], v65 offset:6144
  s_waitcnt vmcnt(14) lgkmcnt(8)
  buffer_load_dwordx4 v[228:231], v61, s[8:11], s35 offen
  s_add_u32 s35, s35, 110592
  v_mfma_f32_16x16x32_bf16 v[100:103], v[236:239], v[148:151], v[100:103]
  v_and_b32 v85, 0xffff0000, v74
  v_mfma_f32_16x16x32_bf16 v[104:107], v[236:239], v[152:155], v[104:107]
  v_mul_f32 v97, v85, v85
  v_mfma_f32_16x16x32_bf16 v[108:111], v[236:239], v[156:159], v[108:111]
  v_fma_f32 v97, v97, v66, s37
  v_mfma_f32_16x16x32_bf16 v[112:115], v[236:239], v[160:163], v[112:115]
  v_mul_f32 v97, v85, v97
  buffer_load_dwordx4 v[232:235], v61, s[8:11], s36 offen
  s_add_u32 s36, s36, 110592
  v_mfma_f32_16x16x32_bf16 v[100:103], v[240:243], v[164:167], v[100:103]
  v_exp_f32 v97, v97
  v_mfma_f32_16x16x32_bf16 v[104:107], v[240:243], v[168:171], v[104:107]
  v_add_f32 v97, 1.0, v97
  v_mfma_f32_16x16x32_bf16 v[108:111], v[240:243], v[172:175], v[108:111]
  v_rcp_f32 v97, v97
  v_mfma_f32_16x16x32_bf16 v[112:115], v[240:243], v[176:179], v[112:115]
  v_mul_f32 v85, v85, v97
  ds_read_b128 v[148:151], v63 offset:8192
  ds_read_b128 v[152:155], v63 offset:10240
  ds_read_b128 v[156:159], v63 offset:12288
  ds_read_b128 v[160:163], v63 offset:14336
  ds_read_b128 v[164:167], v65 offset:8192
  ds_read_b128 v[168:171], v65 offset:10240
  ds_read_b128 v[172:175], v65 offset:12288
  ds_read_b128 v[176:179], v65 offset:14336
  s_waitcnt vmcnt(14) lgkmcnt(8)
  buffer_load_dwordx4 v[236:239], v61, s[8:11], s35 offen
  s_add_u32 s35, s35, 110592
  v_mfma_f32_16x16x32_bf16 v[100:103], v[244:247], v[116:119], v[100:103]
  v_lshlrev_b32 v86, 16, v75
  v_mfma_f32_16x16x32_bf16 v[104:107], v[244:247], v[120:123], v[104:107]
  v_mul_f32 v96, v86, v86
  v_mfma_f32_16x16x32_bf16 v[108:111], v[244:247], v[124:127], v[108:111]
  v_fma_f32 v96, v96, v66, s37
  v_mfma_f32_16x16x32_bf16 v[112:115], v[244:247], v[128:131], v[112:115]
  v_mul_f32 v96, v86, v96
  buffer_load_dwordx4 v[240:243], v61, s[8:11], s36 offen
  s_add_u32 s36, s36, 110592
  v_mfma_f32_16x16x32_bf16 v[100:103], v[248:251], v[132:135], v[100:103]
  v_exp_f32 v96, v96
  v_mfma_f32_16x16x32_bf16 v[104:107], v[248:251], v[136:139], v[104:107]
  v_add_f32 v96, 1.0, v96
  v_mfma_f32_16x16x32_bf16 v[108:111], v[248:251], v[140:143], v[108:111]
  v_rcp_f32 v96, v96
  v_mfma_f32_16x16x32_bf16 v[112:115], v[248:251], v[144:147], v[112:115]
  v_mul_f32 v86, v86, v96
  s_barrier
  s_lshl_b32 s33, s30, 3
  s_add_u32 s33, s33, s54
  s_add_u32 s33, s33, 4096
  s_cmp_eq_u32 s28, 0
  s_cselect_b32 s33, s33, 0x80000000
  v_mov_b32 v54, 0
  s_mov_b64 exec, 1
  buffer_store_dwordx2 v[52:53], v54, s[8:11], s33 offen sc1
  s_mov_b64 exec, -1
  ds_read_b128 v[116:119], v62 offset:0
  ds_read_b128 v[120:123], v62 offset:2048
  ds_read_b128 v[124:127], v62 offset:4096
  ds_read_b128 v[128:131], v62 offset:6144
  ds_read_b128 v[132:135], v64 offset:0
  ds_read_b128 v[136:139], v64 offset:2048
  ds_read_b128 v[140:143], v64 offset:4096
  ds_read_b128 v[144:147], v64 offset:6144
  s_waitcnt vmcnt(15) lgkmcnt(8)
  buffer_load_dwordx4 v[244:247], v61, s[8:11], s35 offen
  s_add_u32 s35, s35, 110592
  v_mfma_f32_16x16x32_bf16 v[100:103], v[180:183], v[148:151], v[100:103]
  v_and_b32 v87, 0xffff0000, v75
  v_mfma_f32_16x16x32_bf16 v[104:107], v[180:183], v[152:155], v[104:107]
  v_mul_f32 v97, v87, v87
  v_mfma_f32_16x16x32_bf16 v[108:111], v[180:183], v[156:159], v[108:111]
  v_fma_f32 v97, v97, v66, s37
  v_mfma_f32_16x16x32_bf16 v[112:115], v[180:183], v[160:163], v[112:115]
  v_mul_f32 v97, v87, v97
  buffer_load_dwordx4 v[248:251], v61, s[8:11], s36 offen
  s_add_u32 s36, s36, 110592
  v_mfma_f32_16x16x32_bf16 v[100:103], v[184:187], v[164:167], v[100:103]
  v_exp_f32 v97, v97
  v_mfma_f32_16x16x32_bf16 v[104:107], v[184:187], v[168:171], v[104:107]
  v_add_f32 v97, 1.0, v97
  v_mfma_f32_16x16x32_bf16 v[108:111], v[184:187], v[172:175], v[108:111]
  v_rcp_f32 v97, v97
  v_mfma_f32_16x16x32_bf16 v[112:115], v[184:187], v[176:179], v[112:115]
  v_mul_f32 v87, v87, v97
  ds_read_b128 v[148:151], v62 offset:8192
  ds_read_b128 v[152:155], v62 offset:10240
  ds_read_b128 v[156:159], v62 offset:12288
  ds_read_b128 v[160:163], v62 offset:14336
  ds_read_b128 v[164:167], v64 offset:8192
  ds_read_b128 v[168:171], v64 offset:10240
  ds_read_b128 v[172:175], v64 offset:12288
  ds_read_b128 v[176:179], v64 offset:14336
  s_waitcnt vmcnt(15) lgkmcnt(8)
  buffer_load_dwordx4 v[180:183], v61, s[8:11], s35 offen
  s_add_u32 s35, s35, 110592
  v_mfma_f32_16x16x32_bf16 v[100:103], v[188:191], v[116:119], v[100:103]
  v_lshlrev_b32 v88, 16, v76
  v_mfma_f32_16x16x32_bf16 v[104:107], v[188:191], v[120:123], v[104:107]
  v_mul_f32 v96, v88, v88
  v_mfma_f32_16x16x32_bf16 v[108:111], v[188:191], v[124:127], v[108:111]
  v_fma_f32 v96, v96, v66, s37
  v_mfma_f32_16x16x32_bf16 v[112:115], v[188:191], v[128:131], v[112:115]
  v_mul_f32 v96, v88, v96
  buffer_load_dwordx4 v[184:187], v61, s[8:11], s36 offen
  s_add_u32 s36, s36, 110592
  v_mfma_f32_16x16x32_bf16 v[100:103], v[192:195], v[132:135], v[100:103]
  v_exp_f32 v96, v96
  v_mfma_f32_16x16x32_bf16 v[104:107], v[192:195], v[136:139], v[104:107]
  v_add_f32 v96, 1.0, v96
  v_mfma_f32_16x16x32_bf16 v[108:111], v[192:195], v[140:143], v[108:111]
  v_rcp_f32 v96, v96
  v_mfma_f32_16x16x32_bf16 v[112:115], v[192:195], v[144:147], v[112:115]
  v_mul_f32 v88, v88, v96
  s_barrier
  ds_read_b128 v[116:119], v62 offset:16384
  ds_read_b128 v[120:123], v62 offset:18432
  ds_read_b128 v[124:127], v62 offset:20480
  ds_read_b128 v[128:131], v62 offset:22528
  ds_read_b128 v[132:135], v64 offset:16384
  ds_read_b128 v[136:139], v64 offset:18432
  ds_read_b128 v[140:143], v64 offset:20480
  ds_read_b128 v[144:147], v64 offset:22528
  s_waitcnt vmcnt(15) lgkmcnt(8)
  buffer_load_dwordx4 v[188:191], v61, s[8:11], s35 offen
  s_add_u32 s35, s35, 110592
  v_mfma_f32_16x16x32_bf16 v[100:103], v[196:199], v[148:151], v[100:103]
  v_and_b32 v89, 0xffff0000, v76
  v_mfma_f32_16x16x32_bf16 v[104:107], v[196:199], v[152:155], v[104:107]
  v_mul_f32 v97, v89, v89
  v_mfma_f32_16x16x32_bf16 v[108:111], v[196:199], v[156:159], v[108:111]
  v_fma_f32 v97, v97, v66, s37
  v_mfma_f32_16x16x32_bf16 v[112:115], v[196:199], v[160:163], v[112:115]
  v_mul_f32 v97, v89, v97
  buffer_load_dwordx4 v[192:195], v61, s[8:11], s36 offen
  s_add_u32 s36, s36, 110592
  v_mfma_f32_16x16x32_bf16 v[100:103], v[200:203], v[164:167], v[100:103]
  v_exp_f32 v97, v97
  v_mfma_f32_16x16x32_bf16 v[104:107], v[200:203], v[168:171], v[104:107]
  v_add_f32 v97, 1.0, v97
  v_mfma_f32_16x16x32_bf16 v[108:111], v[200:203], v[172:175], v[108:111]
  v_rcp_f32 v97, v97
  v_mfma_f32_16x16x32_bf16 v[112:115], v[200:203], v[176:179], v[112:115]
  v_mul_f32 v89, v89, v97
  ds_read_b128 v[148:151], v62 offset:24576
  ds_read_b128 v[152:155], v62 offset:26624
  ds_read_b128 v[156:159], v62 offset:28672
  ds_read_b128 v[160:163], v62 offset:30720
  ds_read_b128 v[164:167], v64 offset:24576
  ds_read_b128 v[168:171], v64 offset:26624
  ds_read_b128 v[172:175], v64 offset:28672
  ds_read_b128 v[176:179], v64 offset:30720
  s_waitcnt vmcnt(15) lgkmcnt(8)
  buffer_load_dwordx4 v[196:199], v61, s[8:11], s35 offen
  s_add_u32 s35, s35, 110592
  v_mfma_f32_16x16x32_bf16 v[100:103], v[204:207], v[116:119], v[100:103]
  v_lshlrev_b32 v90, 16, v77
  v_mfma_f32_16x16x32_bf16 v[104:107], v[204:207], v[120:123], v[104:107]
  v_mul_f32 v96, v90, v90
  v_mfma_f32_16x16x32_bf16 v[108:111], v[204:207], v[124:127], v[108:111]
  v_fma_f32 v96, v96, v66, s37
  v_mfma_f32_16x16x32_bf16 v[112:115], v[204:207], v[128:131], v[112:115]
  v_mul_f32 v96, v90, v96
  buffer_load_dwordx4 v[200:203], v61, s[8:11], s36 offen
  s_add_u32 s36, s36, 110592
  v_mfma_f32_16x16x32_bf16 v[100:103], v[208:211], v[132:135], v[100:103]
  v_exp_f32 v96, v96
  v_mfma_f32_16x16x32_bf16 v[104:107], v[208:211], v[136:139], v[104:107]
  v_add_f32 v96, 1.0, v96
  v_mfma_f32_16x16x32_bf16 v[108:111], v[208:211], v[140:143], v[108:111]
  v_rcp_f32 v96, v96
  v_mfma_f32_16x16x32_bf16 v[112:115], v[208:211], v[144:147], v[112:115]
  v_mul_f32 v90, v90, v96
  s_barrier
  ds_read_b128 v[116:119], v62 offset:32768
  ds_read_b128 v[120:123], v62 offset:34816
  ds_read_b128 v[124:127], v62 offset:36864
  ds_read_b128 v[128:131], v62 offset:38912
  ds_read_b128 v[132:135], v64 offset:32768
  ds_read_b128 v[136:139], v64 offset:34816
  ds_read_b128 v[140:143], v64 offset:36864
  ds_read_b128 v[144:147], v64 offset:38912
  s_waitcnt vmcnt(15) lgkmcnt(8)
  buffer_load_dwordx4 v[204:207], v61, s[8:11], s35 offen
  s_add_u32 s35, s35, 110592
  v_mfma_f32_16x16x32_bf16 v[100:103], v[212:215], v[148:151], v[100:103]
  v_and_b32 v91, 0xffff0000, v77
  v_mfma_f32_16x16x32_bf16 v[104:107], v[212:215], v[152:155], v[104:107]
  v_mul_f32 v97, v91, v91
  v_mfma_f32_16x16x32_bf16 v[108:111], v[212:215], v[156:159], v[108:111]
  v_fma_f32 v97, v97, v66, s37
  v_mfma_f32_16x16x32_bf16 v[112:115], v[212:215], v[160:163], v[112:115]
  v_mul_f32 v97, v91, v97
  buffer_load_dwordx4 v[208:211], v61, s[8:11], s36 offen
  s_add_u32 s36, s36, 110592
  v_mfma_f32_16x16x32_bf16 v[100:103], v[216:219], v[164:167], v[100:103]
  v_exp_f32 v97, v97
  v_mfma_f32_16x16x32_bf16 v[104:107], v[216:219], v[168:171], v[104:107]
  v_add_f32 v97, 1.0, v97
  v_mfma_f32_16x16x32_bf16 v[108:111], v[216:219], v[172:175], v[108:111]
  v_rcp_f32 v97, v97
  v_mfma_f32_16x16x32_bf16 v[112:115], v[216:219], v[176:179], v[112:115]
  v_mul_f32 v91, v91, v97
  ds_read_b128 v[148:151], v62 offset:40960
  ds_read_b128 v[152:155], v62 offset:43008
  ds_read_b128 v[156:159], v62 offset:45056
  ds_read_b128 v[160:163], v62 offset:47104
  ds_read_b128 v[164:167], v64 offset:40960
  ds_read_b128 v[168:171], v64 offset:43008
  ds_read_b128 v[172:175], v64 offset:45056
  ds_read_b128 v[176:179], v64 offset:47104
  s_waitcnt vmcnt(15) lgkmcnt(8)
  buffer_load_dwordx4 v[212:215], v61, s[8:11], s35 offen
  s_add_u32 s35, s35, 110592
  v_mfma_f32_16x16x32_bf16 v[100:103], v[220:223], v[116:119], v[100:103]
  v_lshlrev_b32 v92, 16, v78
  v_mfma_f32_16x16x32_bf16 v[104:107], v[220:223], v[120:123], v[104:107]
  v_mul_f32 v96, v92, v92
  v_mfma_f32_16x16x32_bf16 v[108:111], v[220:223], v[124:127], v[108:111]
  v_fma_f32 v96, v96, v66, s37
  v_mfma_f32_16x16x32_bf16 v[112:115], v[220:223], v[128:131], v[112:115]
  v_mul_f32 v96, v92, v96
  buffer_load_dwordx4 v[216:219], v61, s[8:11], s36 offen
  s_add_u32 s36, s36, 110592
  v_mfma_f32_16x16x32_bf16 v[100:103], v[224:227], v[132:135], v[100:103]
  v_exp_f32 v96, v96
  v_mfma_f32_16x16x32_bf16 v[104:107], v[224:227], v[136:139], v[104:107]
  v_add_f32 v96, 1.0, v96
  v_mfma_f32_16x16x32_bf16 v[108:111], v[224:227], v[140:143], v[108:111]
  v_rcp_f32 v96, v96
  v_mfma_f32_16x16x32_bf16 v[112:115], v[224:227], v[144:147], v[112:115]
  v_mul_f32 v92, v92, v96
  s_barrier
  ds_read_b128 v[116:119], v62 offset:49152
  ds_read_b128 v[120:123], v62 offset:51200
  ds_read_b128 v[124:127], v62 offset:53248
  ds_read_b128 v[128:131], v62 offset:55296
  ds_read_b128 v[132:135], v64 offset:49152
  ds_read_b128 v[136:139], v64 offset:51200
  ds_read_b128 v[140:143], v64 offset:53248
  ds_read_b128 v[144:147], v64 offset:55296
  s_waitcnt vmcnt(15) lgkmcnt(8)
  buffer_load_dwordx4 v[220:223], v61, s[8:11], s35 offen
  s_add_u32 s35, s35, 110592
  v_mfma_f32_16x16x32_bf16 v[100:103], v[228:231], v[148:151], v[100:103]
  v_and_b32 v93, 0xffff0000, v78
  v_mfma_f32_16x16x32_bf16 v[104:107], v[228:231], v[152:155], v[104:107]
  v_mul_f32 v97, v93, v93
  v_mfma_f32_16x16x32_bf16 v[108:111], v[228:231], v[156:159], v[108:111]
  v_fma_f32 v97, v97, v66, s37
  v_mfma_f32_16x16x32_bf16 v[112:115], v[228:231], v[160:163], v[112:115]
  v_mul_f32 v97, v93, v97
  buffer_load_dwordx4 v[224:227], v61, s[8:11], s36 offen
  s_add_u32 s36, s36, 110592
  v_mfma_f32_16x16x32_bf16 v[100:103], v[232:235], v[164:167], v[100:103]
  v_exp_f32 v97, v97
  v_mfma_f32_16x16x32_bf16 v[104:107], v[232:235], v[168:171], v[104:107]
  v_add_f32 v97, 1.0, v97
  v_mfma_f32_16x16x32_bf16 v[108:111], v[232:235], v[172:175], v[108:111]
  v_rcp_f32 v97, v97
  v_mfma_f32_16x16x32_bf16 v[112:115], v[232:235], v[176:179], v[112:115]
  v_mul_f32 v93, v93, v97
  ds_read_b128 v[148:151], v62 offset:57344
  ds_read_b128 v[152:155], v62 offset:59392
  ds_read_b128 v[156:159], v62 offset:61440
  ds_read_b128 v[160:163], v62 offset:63488
  ds_read_b128 v[164:167], v64 offset:57344
  ds_read_b128 v[168:171], v64 offset:59392
  ds_read_b128 v[172:175], v64 offset:61440
  ds_read_b128 v[176:179], v64 offset:63488
  s_waitcnt vmcnt(15) lgkmcnt(8)
  buffer_load_dwordx4 v[228:231], v61, s[8:11], s35 offen
  s_add_u32 s35, s35, 110592
  v_mfma_f32_16x16x32_bf16 v[100:103], v[236:239], v[116:119], v[100:103]
  v_lshlrev_b32 v94, 16, v79
  v_mfma_f32_16x16x32_bf16 v[104:107], v[236:239], v[120:123], v[104:107]
  v_mul_f32 v96, v94, v94
  v_mfma_f32_16x16x32_bf16 v[108:111], v[236:239], v[124:127], v[108:111]
  v_fma_f32 v96, v96, v66, s37
  v_mfma_f32_16x16x32_bf16 v[112:115], v[236:239], v[128:131], v[112:115]
  v_mul_f32 v96, v94, v96
  buffer_load_dwordx4 v[232:235], v61, s[8:11], s36 offen
  s_add_u32 s36, s36, 110592
  v_mfma_f32_16x16x32_bf16 v[100:103], v[240:243], v[132:135], v[100:103]
  v_exp_f32 v96, v96
  v_mfma_f32_16x16x32_bf16 v[104:107], v[240:243], v[136:139], v[104:107]
  v_add_f32 v96, 1.0, v96
  v_mfma_f32_16x16x32_bf16 v[108:111], v[240:243], v[140:143], v[108:111]
  v_rcp_f32 v96, v96
  v_mfma_f32_16x16x32_bf16 v[112:115], v[240:243], v[144:147], v[112:115]
  v_mul_f32 v94, v94, v96
  s_barrier
  ds_read_b128 v[116:119], v63 offset:0
  ds_read_b128 v[120:123], v63 offset:2048
  ds_read_b128 v[124:127], v63 offset:4096
  ds_read_b128 v[128:131], v63 offset:6144
  ds_read_b128 v[132:135], v65 offset:0
  ds_read_b128 v[136:139], v65 offset:2048
  ds_read_b128 v[140:143], v65 offset:4096
  ds_read_b128 v[144:147], v65 offset:6144
  s_waitcnt vmcnt(14) lgkmcnt(8)
  buffer_load_dwordx4 v[236:239], v61, s[8:11], s35 offen
  s_add_u32 s35, s35, 110592
  v_mfma_f32_16x16x32_bf16 v[100:103], v[244:247], v[148:151], v[100:103]
  v_and_b32 v95, 0xffff0000, v79
  v_mfma_f32_16x16x32_bf16 v[104:107], v[244:247], v[152:155], v[104:107]
  v_mul_f32 v97, v95, v95
  v_mfma_f32_16x16x32_bf16 v[108:111], v[244:247], v[156:159], v[108:111]
  v_fma_f32 v97, v97, v66, s37
  v_mfma_f32_16x16x32_bf16 v[112:115], v[244:247], v[160:163], v[112:115]
  v_mul_f32 v97, v95, v97
  buffer_load_dwordx4 v[240:243], v61, s[8:11], s36 offen
  s_add_u32 s36, s36, 110592
  v_mfma_f32_16x16x32_bf16 v[100:103], v[248:251], v[164:167], v[100:103]
  v_exp_f32 v97, v97
  v_mfma_f32_16x16x32_bf16 v[104:107], v[248:251], v[168:171], v[104:107]
  v_add_f32 v97, 1.0, v97
  v_mfma_f32_16x16x32_bf16 v[108:111], v[248:251], v[172:175], v[108:111]
  v_rcp_f32 v97, v97
  v_mfma_f32_16x16x32_bf16 v[112:115], v[248:251], v[176:179], v[112:115]
  v_mul_f32 v95, v95, v97
  ds_read_b128 v[148:151], v63 offset:8192
  ds_read_b128 v[152:155], v63 offset:10240
  ds_read_b128 v[156:159], v63 offset:12288
  ds_read_b128 v[160:163], v63 offset:14336
  ds_read_b128 v[164:167], v65 offset:8192
  ds_read_b128 v[168:171], v65 offset:10240
  ds_read_b128 v[172:175], v65 offset:12288
  ds_read_b128 v[176:179], v65 offset:14336
  s_waitcnt vmcnt(14) lgkmcnt(8)
  buffer_load_dwordx4 v[244:247], v61, s[8:11], s35 offen
  s_add_u32 s35, s35, 110592
  v_mfma_f32_16x16x32_bf16 v[100:103], v[180:183], v[116:119], v[100:103]
  v_and_b32 v56, 7, v0
  v_lshlrev_b32 v56, 3, v56
  v_and_b32 v72, 63, v0
  v_mfma_f32_16x16x32_bf16 v[104:107], v[180:183], v[120:123], v[104:107]
  v_lshlrev_b32 v1, 4, v72
  v_lshrrev_b32 v73, 5, v72
  v_lshlrev_b32 v73, 4, v73
  v_mfma_f32_16x16x32_bf16 v[108:111], v[180:183], v[124:127], v[108:111]
  v_lshrrev_b32 v74, 4, v72
  v_and_b32 v74, 1, v74
  v_lshlrev_b32 v74, 2, v74
  v_mfma_f32_16x16x32_bf16 v[112:115], v[180:183], v[128:131], v[112:115]
  v_add_u32 v73, v73, v74
  v_lshrrev_b32 v74, 2, v72
  v_and_b32 v74, 3, v74
  buffer_load_dwordx4 v[248:251], v61, s[8:11], s36 offen
  s_add_u32 s36, s36, 110592
  v_mfma_f32_16x16x32_bf16 v[100:103], v[184:187], v[132:135], v[100:103]
  v_add_u32 v73, v73, v74
  v_mul_u32_u24 v73, 160, v73
  v_and_b32 v74, 3, v72
  v_mfma_f32_16x16x32_bf16 v[104:107], v[184:187], v[136:139], v[104:107]
  v_lshlrev_b32 v74, 3, v74
  v_add_u32 v73, v73, v74
  v_mov_b32 v73, v1
  v_mfma_f32_16x16x32_bf16 v[108:111], v[184:187], v[140:143], v[108:111]
  s_mul_i32 s50, s41, 5120
  s_add_u32 s50, s50, 0
  v_add_u32 v2, s50, v73
  v_mfma_f32_16x16x32_bf16 v[112:115], v[184:187], v[144:147], v[112:115]
  v_add_u32 v3, 0x10000, v2
  v_add_u32 v4, 0x20000, v2
  s_lshl_b32 s50, s29, 6
  s_barrier
  ds_read_b128 v[116:119], v62 offset:0
  ds_read_b128 v[120:123], v62 offset:2048
  ds_read_b128 v[124:127], v62 offset:4096
  ds_read_b128 v[128:131], v62 offset:6144
  ds_read_b128 v[132:135], v64 offset:0
  ds_read_b128 v[136:139], v64 offset:2048
  ds_read_b128 v[140:143], v64 offset:4096
  ds_read_b128 v[144:147], v64 offset:6144
  s_waitcnt vmcnt(14) lgkmcnt(8)
  buffer_load_dwordx4 v[180:183], v61, s[8:11], s35 offen
  s_add_u32 s35, s35, 110592
  v_mfma_f32_16x16x32_bf16 v[100:103], v[188:191], v[148:151], v[100:103]
  s_mul_i32 s50, s50, 1280
  s_mul_i32 s51, s30, 160
  s_add_u32 s50, s50, s51
  v_mfma_f32_16x16x32_bf16 v[104:107], v[188:191], v[152:155], v[104:107]
  v_and_b32 v73, 15, v72
  v_lshrrev_b32 v74, 4, v72
  s_lshl_b32 s50, s29, 6
  v_mfma_f32_16x16x32_bf16 v[108:111], v[188:191], v[156:159], v[108:111]
  s_lshl_b32 s51, s42, 4
  s_add_u32 s50, s50, s51
  s_mul_i32 s50, s50, 1280
  v_mfma_f32_16x16x32_bf16 v[112:115], v[188:191], v[160:163], v[112:115]
  s_mul_i32 s51, s30, 160
  s_add_u32 s50, s50, s51
  v_mul_u32_u24 v73, 1280, v73
  buffer_load_dwordx4 v[184:187], v61, s[8:11], s36 offen
  s_add_u32 s36, s36, 110592
  v_mfma_f32_16x16x32_bf16 v[100:103], v[192:195], v[164:167], v[100:103]
  v_add_u32 v73, s50, v73
  v_lshl_add_u32 v7, v74, 3, v73
  s_and_b32 s51, s30, 1
  v_mfma_f32_16x16x32_bf16 v[104:107], v[192:195], v[168:171], v[104:107]
  s_cmp_eq_u32 s51, 0
  s_cselect_b32 s50, 128, 0
  v_add_u32 v7, s50, v7
  s_cmp_eq_u32 s41, 0
  s_cselect_b32 s50, 0, 0x80000000
  v_mfma_f32_16x16x32_bf16 v[108:111], v[192:195], v[172:175], v[108:111]
  v_or_b32 v7, s50, v7
  v_and_b32 v75, 1, v74
  v_lshl_add_u32 v73, v75, 5, v73
  v_mfma_f32_16x16x32_bf16 v[112:115], v[192:195], v[176:179], v[112:115]
  v_lshrrev_b32 v75, 1, v74
  v_lshl_add_u32 v73, v75, 4, v73
  s_lshl_b32 s50, s41, 6
  s_add_u32 s33, s54, 4096
  s_cmp_eq_u32 s28, 0
  s_cselect_b32 s33, s33, 0x80000000
  buffer_load_dwordx2 v[54:55], v56, s[8:11], s33 offen sc1
  ds_read_b128 v[148:151], v62 offset:8192
  ds_read_b128 v[152:155], v62 offset:10240
  ds_read_b128 v[156:159], v62 offset:12288
  ds_read_b128 v[160:163], v62 offset:14336
  ds_read_b128 v[164:167], v64 offset:8192
  ds_read_b128 v[168:171], v64 offset:10240
  ds_read_b128 v[172:175], v64 offset:12288
  ds_read_b128 v[176:179], v64 offset:14336
  s_waitcnt vmcnt(15) lgkmcnt(8)
  buffer_load_dwordx4 v[188:191], v61, s[8:11], s35 offen
  s_add_u32 s35, s35, 110592
  v_mfma_f32_16x16x32_bf16 v[100:103], v[196:199], v[116:119], v[100:103]
  s_lshl_b32 s51, s51, 5
  s_add_u32 s50, s50, s51
  v_add_u32 v6, s50, v73
  v_mfma_f32_16x16x32_bf16 v[104:107], v[196:199], v[120:123], v[104:107]
  s_mul_i32 s50, s42, 5120
  v_add_u32 v8, s50, v1
  s_mul_i32 s43, s30, 240640
  v_mfma_f32_16x16x32_bf16 v[108:111], v[196:199], v[124:127], v[108:111]
  s_mul_i32 s50, s28, 1024
  s_add_u32 s43, s43, s50
  s_add_u32 s43, s43, 25304064
  v_mfma_f32_16x16x32_bf16 v[112:115], v[196:199], v[128:131], v[112:115]
  s_add_u32 s46, s50, 0
  s_lshl_b32 s50, s29, 2
  s_add_u32 s50, s50, s42
  buffer_load_dwordx4 v[192:195], v61, s[8:11], s36 offen
  s_add_u32 s36, s36, 110592
  v_mfma_f32_16x16x32_bf16 v[100:103], v[200:203], v[132:135], v[100:103]
  s_mul_i32 s44, s50, 27648
  s_lshl_b32 s51, s41, 10
  s_add_u32 s44, s44, s51
  v_mfma_f32_16x16x32_bf16 v[104:107], v[200:203], v[136:139], v[104:107]
  s_add_u32 s44, s44, 7340032
  s_mul_i32 s45, s50, 20480
  s_add_u32 s45, s45, s51
  v_mfma_f32_16x16x32_bf16 v[108:111], v[200:203], v[140:143], v[108:111]
  s_add_u32 s45, s45, 11010048
  v_lshlrev_b32 v68, 16, v68
  v_mov_b32 v70, v68
  v_mfma_f32_16x16x32_bf16 v[112:115], v[200:203], v[144:147], v[112:115]
  s_nop 0
  v_permlane32_swap_b32 v68, v70
  v_mov_b32 v69, v68
  v_mov_b32 v71, v70
  s_barrier
  ds_read_b128 v[116:119], v62 offset:16384
  ds_read_b128 v[120:123], v62 offset:18432
  ds_read_b128 v[124:127], v62 offset:20480
  ds_read_b128 v[128:131], v62 offset:22528
  ds_read_b128 v[132:135], v64 offset:16384
  ds_read_b128 v[136:139], v64 offset:18432
  ds_read_b128 v[140:143], v64 offset:20480
  ds_read_b128 v[144:147], v64 offset:22528
  s_waitcnt vmcnt(15) lgkmcnt(8)
  buffer_load_dwordx4 v[196:199], v61, s[8:11], s35 offen
  s_add_u32 s35, s35, 110592
  v_mfma_f32_16x16x32_bf16 v[100:103], v[204:207], v[148:151], v[100:103]
  v_permlane16_swap_b32 v68, v69
  v_permlane16_swap_b32 v70, v71
  v_mfma_f32_16x16x32_bf16 v[104:107], v[204:207], v[152:155], v[104:107]
  v_mfma_f32_16x16x32_bf16 v[108:111], v[204:207], v[156:159], v[108:111]
  v_mfma_f32_16x16x32_bf16 v[112:115], v[204:207], v[160:163], v[112:115]
  buffer_load_dwordx4 v[200:203], v61, s[8:11], s36 offen
  s_add_u32 s36, s36, 110592
  v_mfma_f32_16x16x32_bf16 v[100:103], v[208:211], v[164:167], v[100:103]
  v_mfma_f32_16x16x32_bf16 v[104:107], v[208:211], v[168:171], v[104:107]
  v_mfma_f32_16x16x32_bf16 v[108:111], v[208:211], v[172:175], v[108:111]
  v_mfma_f32_16x16x32_bf16 v[112:115], v[208:211], v[176:179], v[112:115]
  ds_read_b128 v[148:151], v62 offset:24576
  ds_read_b128 v[152:155], v62 offset:26624
  ds_read_b128 v[156:159], v62 offset:28672
  ds_read_b128 v[160:163], v62 offset:30720
  ds_read_b128 v[164:167], v64 offset:24576
  ds_read_b128 v[168:171], v64 offset:26624
  ds_read_b128 v[172:175], v64 offset:28672
  ds_read_b128 v[176:179], v64 offset:30720
  s_waitcnt vmcnt(15) lgkmcnt(8)
  buffer_load_dwordx4 v[204:207], v61, s[8:11], s35 offen
  s_add_u32 s35, s35, 110592
  v_mfma_f32_16x16x32_bf16 v[100:103], v[212:215], v[116:119], v[100:103]
  v_mfma_f32_16x16x32_bf16 v[104:107], v[212:215], v[120:123], v[104:107]
  v_mfma_f32_16x16x32_bf16 v[108:111], v[212:215], v[124:127], v[108:111]
  v_mfma_f32_16x16x32_bf16 v[112:115], v[212:215], v[128:131], v[112:115]
  buffer_load_dwordx4 v[208:211], v61, s[8:11], s36 offen
  s_add_u32 s36, s36, 110592
  v_mfma_f32_16x16x32_bf16 v[100:103], v[216:219], v[132:135], v[100:103]
  v_mfma_f32_16x16x32_bf16 v[104:107], v[216:219], v[136:139], v[104:107]
  v_mfma_f32_16x16x32_bf16 v[108:111], v[216:219], v[140:143], v[108:111]
  v_mfma_f32_16x16x32_bf16 v[112:115], v[216:219], v[144:147], v[112:115]
  s_cmp_lg_u32 s28, 0
  s_cbranch_scc1 K2_ook
  s_waitcnt vmcnt(6)
  v_cmp_ne_u32 vcc, s52, v54
  s_nop 3
  s_mov_b64 s[48:49], vcc
  v_cmp_ne_u32 vcc, s53, v55
  s_nop 3
  s_or_b64 s[48:49], s[48:49], vcc
  s_cmp_lg_u64 s[48:49], 0
  s_cbranch_scc1 K2_ospin
K2_ook:
  s_barrier
  ds_read_b128 v[116:119], v62 offset:32768
  ds_read_b128 v[120:123], v62 offset:34816
  ds_read_b128 v[124:127], v62 offset:36864
  ds_read_b128 v[128:131], v62 offset:38912
  ds_read_b128 v[132:135], v64 offset:32768
  ds_read_b128 v[136:139], v64 offset:34816
  ds_read_b128 v[140:143], v64 offset:36864
  ds_read_b128 v[144:147], v64 offset:38912
  s_waitcnt vmcnt(15) lgkmcnt(8)
  buffer_load_dwordx4 v[212:215], v61, s[8:11], s35 offen
  s_add_u32 s35, s35, 110592
  v_mfma_f32_16x16x32_bf16 v[100:103], v[220:223], v[148:151], v[100:103]
  v_mfma_f32_16x16x32_bf16 v[104:107], v[220:223], v[152:155], v[104:107]
  v_mfma_f32_16x16x32_bf16 v[108:111], v[220:223], v[156:159], v[108:111]
  v_mfma_f32_16x16x32_bf16 v[112:115], v[220:223], v[160:163], v[112:115]
  buffer_load_dwordx4 v[216:219], v61, s[8:11], s36 offen
  s_add_u32 s36, s36, 110592
  v_mfma_f32_16x16x32_bf16 v[100:103], v[224:227], v[164:167], v[100:103]
  v_mfma_f32_16x16x32_bf16 v[104:107], v[224:227], v[168:171], v[104:107]
  v_mfma_f32_16x16x32_bf16 v[108:111], v[224:227], v[172:175], v[108:111]
  v_mfma_f32_16x16x32_bf16 v[112:115], v[224:227], v[176:179], v[112:115]
  ds_read_b128 v[148:151], v62 offset:40960
  ds_read_b128 v[152:155], v62 offset:43008
  ds_read_b128 v[156:159], v62 offset:45056
  ds_read_b128 v[160:163], v62 offset:47104
  ds_read_b128 v[164:167], v64 offset:40960
  ds_read_b128 v[168:171], v64 offset:43008
  ds_read_b128 v[172:175], v64 offset:45056
  ds_read_b128 v[176:179], v64 offset:47104
  s_waitcnt vmcnt(15) lgkmcnt(8)
  s_add_u32 m0, s46, 81920
  s_nop 0
  buffer_load_dwordx4 v1, s[8:11], s43 offen lds
  s_add_u32 s43, s43, 8192
  v_mfma_f32_16x16x32_bf16 v[100:103], v[228:231], v[116:119], v[100:103]
  v_mfma_f32_16x16x32_bf16 v[104:107], v[228:231], v[120:123], v[104:107]
  v_mfma_f32_16x16x32_bf16 v[108:111], v[228:231], v[124:127], v[108:111]
  s_add_u32 m0, s46, 90112
  s_nop 0
  buffer_load_dwordx4 v1, s[8:11], s43 offen lds
  s_add_u32 s43, s43, 8192
  v_mfma_f32_16x16x32_bf16 v[112:115], v[228:231], v[128:131], v[112:115]
  v_mfma_f32_16x16x32_bf16 v[100:103], v[232:235], v[132:135], v[100:103]
  v_mfma_f32_16x16x32_bf16 v[104:107], v[232:235], v[136:139], v[104:107]
  buffer_load_dwordx4 v[20:23], v1, s[8:11], s45 offen
  s_add_u32 s45, s45, 2048
  v_mfma_f32_16x16x32_bf16 v[108:111], v[232:235], v[140:143], v[108:111]
  v_mfma_f32_16x16x32_bf16 v[112:115], v[232:235], v[144:147], v[112:115]
  s_barrier
  ds_read_b128 v[116:119], v62 offset:49152
  ds_read_b128 v[120:123], v62 offset:51200
  ds_read_b128 v[124:127], v62 offset:53248
  ds_read_b128 v[128:131], v62 offset:55296
  ds_read_b128 v[132:135], v64 offset:49152
  ds_read_b128 v[136:139], v64 offset:51200
  ds_read_b128 v[140:143], v64 offset:53248
  ds_read_b128 v[144:147], v64 offset:55296
  s_waitcnt vmcnt(16) lgkmcnt(8)
  s_add_u32 m0, s46, 98304
  s_nop 0
  buffer_load_dwordx4 v1, s[8:11], s43 offen lds
  s_add_u32 s43, s43, 8192
  v_mfma_f32_16x16x32_bf16 v[100:103], v[236:239], v[148:151], v[100:103]
  v_mfma_f32_16x16x32_bf16 v[104:107], v[236:239], v[152:155], v[104:107]
  v_mfma_f32_16x16x32_bf16 v[108:111], v[236:239], v[156:159], v[108:111]
  buffer_load_dwordx4 v[24:27], v1, s[8:11], s45 offen
  s_add_u32 s45, s45, 2048
  v_mfma_f32_16x16x32_bf16 v[112:115], v[236:239], v[160:163], v[112:115]
  v_mfma_f32_16x16x32_bf16 v[100:103], v[240:243], v[164:167], v[100:103]
  v_mfma_f32_16x16x32_bf16 v[104:107], v[240:243], v[168:171], v[104:107]
  s_add_u32 m0, s46, 106496
  s_nop 0
  buffer_load_dwordx4 v1, s[8:11], s43 offen lds
  s_add_u32 s43, s43, 8192
  v_mfma_f32_16x16x32_bf16 v[108:111], v[240:243], v[172:175], v[108:111]
  v_mfma_f32_16x16x32_bf16 v[112:115], v[240:243], v[176:179], v[112:115]
  ds_read_b128 v[148:151], v62 offset:57344
  ds_read_b128 v[152:155], v62 offset:59392
  ds_read_b128 v[156:159], v62 offset:61440
  ds_read_b128 v[160:163], v62 offset:63488
  ds_read_b128 v[164:167], v64 offset:57344
  ds_read_b128 v[168:171], v64 offset:59392
  ds_read_b128 v[172:175], v64 offset:61440
  ds_read_b128 v[176:179], v64 offset:63488
  s_waitcnt vmcnt(17) lgkmcnt(8)
  buffer_load_dwordx4 v[28:31], v1, s[8:11], s45 offen
  s_add_u32 s45, s45, 2048
  v_mfma_f32_16x16x32_bf16 v[100:103], v[244:247], v[116:119], v[100:103]
  v_mfma_f32_16x16x32_bf16 v[104:107], v[244:247], v[120:123], v[104:107]
  v_mfma_f32_16x16x32_bf16 v[108:111], v[244:247], v[124:127], v[108:111]
  s_add_u32 m0, s46, 114688
  s_nop 0
  buffer_load_dwordx4 v1, s[8:11], s43 offen lds
  s_add_u32 s43, s43, 8192
  v_mfma_f32_16x16x32_bf16 v[112:115], v[244:247], v[128:131], v[112:115]
  v_mfma_f32_16x16x32_bf16 v[100:103], v[248:251], v[132:135], v[100:103]
  v_mfma_f32_16x16x32_bf16 v[104:107], v[248:251], v[136:139], v[104:107]
  buffer_load_dwordx4 v[32:35], v1, s[8:11], s45 offen
  s_add_u32 s45, s45, 2048
  v_mfma_f32_16x16x32_bf16 v[108:111], v[248:251], v[140:143], v[108:111]
  v_mfma_f32_16x16x32_bf16 v[112:115], v[248:251], v[144:147], v[112:115]
  s_barrier
  ds_read_b128 v[116:119], v63 offset:0
  ds_read_b128 v[120:123], v63 offset:2048
  ds_read_b128 v[124:127], v63 offset:4096
  ds_read_b128 v[128:131], v63 offset:6144
  ds_read_b128 v[132:135], v65 offset:0
  ds_read_b128 v[136:139], v65 offset:2048
  ds_read_b128 v[140:143], v65 offset:4096
  ds_read_b128 v[144:147], v65 offset:6144
  s_waitcnt vmcnt(18) lgkmcnt(8)
  s_add_u32 m0, s46, 122880
  s_nop 0
  buffer_load_dwordx4 v1, s[8:11], s43 offen lds
  s_add_u32 s43, s43, 8192
  v_mfma_f32_16x16x32_bf16 v[100:103], v[180:183], v[148:151], v[100:103]
  v_mfma_f32_16x16x32_bf16 v[104:107], v[180:183], v[152:155], v[104:107]
  v_mfma_f32_16x16x32_bf16 v[108:111], v[180:183], v[156:159], v[108:111]
  s_add_u32 m0, s46, 131072
  s_nop 0
  buffer_load_dwordx4 v1, s[8:11], s43 offen lds
  s_add_u32 s43, s43, 8192
  v_mfma_f32_16x16x32_bf16 v[112:115], v[180:183], v[160:163], v[112:115]
  v_mfma_f32_16x16x32_bf16 v[100:103], v[184:187], v[164:167], v[100:103]
  v_mfma_f32_16x16x32_bf16 v[104:107], v[184:187], v[168:171], v[104:107]
  buffer_load_dwordx4 v[36:39], v1, s[8:11], s45 offen
  s_add_u32 s45, s45, 2048
  v_mfma_f32_16x16x32_bf16 v[108:111], v[184:187], v[172:175], v[108:111]
  v_mfma_f32_16x16x32_bf16 v[112:115], v[184:187], v[176:179], v[112:115]
  ds_read_b128 v[148:151], v63 offset:8192
  ds_read_b128 v[152:155], v63 offset:10240
  ds_read_b128 v[156:159], v63 offset:12288
  ds_read_b128 v[160:163], v63 offset:14336
  ds_read_b128 v[164:167], v65 offset:8192
  ds_read_b128 v[168:171], v65 offset:10240
  ds_read_b128 v[172:175], v65 offset:12288
  ds_read_b128 v[176:179], v65 offset:14336
  s_waitcnt vmcnt(18) lgkmcnt(8)
  s_add_u32 m0, s46, 139264
  s_nop 0
  buffer_load_dwordx4 v1, s[8:11], s43 offen lds
  s_add_u32 s43, s43, 8192
  v_mfma_f32_16x16x32_bf16 v[100:103], v[188:191], v[116:119], v[100:103]
  v_mfma_f32_16x16x32_bf16 v[104:107], v[188:191], v[120:123], v[104:107]
  v_mfma_f32_16x16x32_bf16 v[108:111], v[188:191], v[124:127], v[108:111]
  v_mfma_f32_16x16x32_bf16 v[112:115], v[188:191], v[128:131], v[112:115]
  buffer_load_dwordx4 v[40:43], v1, s[8:11], s45 offen
  s_add_u32 s45, s45, 2048
  v_mfma_f32_16x16x32_bf16 v[100:103], v[192:195], v[132:135], v[100:103]
  v_mfma_f32_16x16x32_bf16 v[104:107], v[192:195], v[136:139], v[104:107]
  v_mfma_f32_16x16x32_bf16 v[108:111], v[192:195], v[140:143], v[108:111]
  v_mfma_f32_16x16x32_bf16 v[112:115], v[192:195], v[144:147], v[112:115]
  s_barrier
  ds_read_b128 v[116:119], v62 offset:0
  ds_read_b128 v[120:123], v62 offset:2048
  ds_read_b128 v[124:127], v62 offset:4096
  ds_read_b128 v[128:131], v62 offset:6144
  ds_read_b128 v[132:135], v64 offset:0
  ds_read_b128 v[136:139], v64 offset:2048
  ds_read_b128 v[140:143], v64 offset:4096
  ds_read_b128 v[144:147], v64 offset:6144
  s_waitcnt vmcnt(18) lgkmcnt(8)
  s_add_u32 m0, s46, 147456
  s_nop 0
  buffer_load_dwordx4 v1, s[8:11], s43 offen lds
  s_add_u32 s43, s43, 8192
  v_mfma_f32_16x16x32_bf16 v[100:103], v[196:199], v[148:151], v[100:103]
  v_mfma_f32_16x16x32_bf16 v[104:107], v[196:199], v[152:155], v[104:107]
  v_mfma_f32_16x16x32_bf16 v[108:111], v[196:199], v[156:159], v[108:111]
  v_mfma_f32_16x16x32_bf16 v[112:115], v[196:199], v[160:163], v[112:115]
  buffer_load_dwordx4 v[44:47], v1, s[8:11], s45 offen
  s_add_u32 s45, s45, 2048
  v_mfma_f32_16x16x32_bf16 v[100:103], v[200:203], v[164:167], v[100:103]
  v_mfma_f32_16x16x32_bf16 v[104:107], v[200:203], v[168:171], v[104:107]
  v_mfma_f32_16x16x32_bf16 v[108:111], v[200:203], v[172:175], v[108:111]
  v_mfma_f32_16x16x32_bf16 v[112:115], v[200:203], v[176:179], v[112:115]
  ds_read_b128 v[148:151], v62 offset:8192
  ds_read_b128 v[152:155], v62 offset:10240
  ds_read_b128 v[156:159], v62 offset:12288
  ds_read_b128 v[160:163], v62 offset:14336
  ds_read_b128 v[164:167], v64 offset:8192
  ds_read_b128 v[168:171], v64 offset:10240
  ds_read_b128 v[172:175], v64 offset:12288
  ds_read_b128 v[176:179], v64 offset:14336
  s_waitcnt vmcnt(18) lgkmcnt(8)
  s_add_u32 m0, s46, 155648
  s_nop 0
  buffer_load_dwordx4 v1, s[8:11], s43 offen lds
  s_add_u32 s43, s43, 8192
  v_mfma_f32_16x16x32_bf16 v[100:103], v[204:207], v[116:119], v[100:103]
  v_mfma_f32_16x16x32_bf16 v[104:107], v[204:207], v[120:123], v[104:107]
  v_mfma_f32_16x16x32_bf16 v[108:111], v[204:207], v[124:127], v[108:111]
  v_mfma_f32_16x16x32_bf16 v[112:115], v[204:207], v[128:131], v[112:115]
  buffer_load_dwordx4 v[48:51], v1, s[8:11], s45 offen
  s_add_u32 s45, s45, 2048
  v_mfma_f32_16x16x32_bf16 v[100:103], v[208:211], v[132:135], v[100:103]
  v_mfma_f32_16x16x32_bf16 v[104:107], v[208:211], v[136:139], v[104:107]
  v_mfma_f32_16x16x32_bf16 v[108:111], v[208:211], v[140:143], v[108:111]
  v_mfma_f32_16x16x32_bf16 v[112:115], v[208:211], v[144:147], v[112:115]
  s_waitcnt vmcnt(18) lgkmcnt(0)
  v_mfma_f32_16x16x32_bf16 v[100:103], v[212:215], v[148:151], v[100:103]
  v_mfma_f32_16x16x32_bf16 v[104:107], v[212:215], v[152:155], v[104:107]
  v_mfma_f32_16x16x32_bf16 v[108:111], v[212:215], v[156:159], v[108:111]
  v_mfma_f32_16x16x32_bf16 v[112:115], v[212:215], v[160:163], v[112:115]
  v_mfma_f32_16x16x32_bf16 v[100:103], v[216:219], v[164:167], v[100:103]
  v_mfma_f32_16x16x32_bf16 v[104:107], v[216:219], v[168:171], v[104:107]
  v_mfma_f32_16x16x32_bf16 v[108:111], v[216:219], v[172:175], v[108:111]
  v_mfma_f32_16x16x32_bf16 v[112:115], v[216:219], v[176:179], v[112:115]
  s_nop 4
  v_add_f32 v100, v100, v68
  v_add_f32 v101, v101, v68
  v_add_f32 v102, v102, v68
  v_add_f32 v103, v103, v68
  v_add_f32 v104, v104, v69
  v_add_f32 v105, v105, v69
  v_add_f32 v106, v106, v69
  v_add_f32 v107, v107, v69
  v_add_f32 v108, v108, v70
  v_add_f32 v109, v109, v70
  v_add_f32 v110, v110, v70
  v_add_f32 v111, v111, v70
  v_add_f32 v112, v112, v71
  v_add_f32 v113, v113, v71
  v_add_f32 v114, v114, v71
  v_add_f32 v115, v115, v71
  v_mul_f32 v100, v100, v80
  v_mul_f32 v101, v101, v81
  v_mul_f32 v102, v102, v82
  v_mul_f32 v103, v103, v83
  v_mul_f32 v104, v104, v84
  v_mul_f32 v105, v105, v85
  v_mul_f32 v106, v106, v86
  v_mul_f32 v107, v107, v87
  v_mul_f32 v108, v108, v88
  v_mul_f32 v109, v109, v89
  v_mul_f32 v110, v110, v90
  v_mul_f32 v111, v111, v91
  v_mul_f32 v112, v112, v92
  v_mul_f32 v113, v113, v93
  v_mul_f32 v114, v114, v94
  v_mul_f32 v115, v115, v95
  v_cvt_pk_bf16_f32 v100, v100, v101
  v_cvt_pk_bf16_f32 v101, v102, v103
  v_cvt_pk_bf16_f32 v102, v104, v105
  v_cvt_pk_bf16_f32 v103, v106, v107
  v_cvt_pk_bf16_f32 v104, v108, v109
  v_cvt_pk_bf16_f32 v105, v110, v111
  v_cvt_pk_bf16_f32 v106, v112, v113
  v_cvt_pk_bf16_f32 v107, v114, v115
  buffer_store_dwordx2 v[100:101], v98, s[8:11], 0 offen sc1
  buffer_store_dwordx2 v[102:103], v98, s[8:11], s38 offen sc1
  buffer_store_dwordx2 v[104:105], v98, s[8:11], s39 offen sc1
  buffer_store_dwordx2 v[106:107], v98, s[8:11], s40 offen sc1
  s_branch K2_p3
K2_helper:
  s_cmp_eq_u32 s28, 7
  s_cbranch_scc1 K2_loader
  v_and_b32 v45, 63, v0
  v_and_b32 v46, 15, v45
  v_lshrrev_b32 v47, 4, v45
  v_lshlrev_b32 v43, 4, v46
  v_lshl_add_u32 v42, v47, 8, v43
  v_add_u32 v34, s57, v42
  s_add_u32 s33, s57, 1152
  v_mul_u32_u24 v42, 384, v47
  v_add_u32 v42, v42, v43
  v_add_u32 v35, s33, v42
  s_add_u32 s33, s33, 1536
  v_add_u32 v36, s33, v43
  s_add_u32 s33, s57, 3072
  v_and_b32 v42, 3, v45
  v_mul_u32_u24 v42, 384, v42
  v_lshrrev_b32 v43, 2, v45
  v_lshl_add_u32 v42, v43, 4, v42
  v_add_u32 v37, s33, v42
  s_mul_i32 s33, s60, 5
  v_add_u32 v42, s33, v47
  v_lshrrev_b32 v43, 1, v42
  v_lshlrev_b32 v43, 10, v43
  v_and_b32 v42, 1, v42
  v_lshl_add_u32 v42, v42, 3, v43
  v_lshlrev_b32 v43, 5, v46
  v_add_u32 v42, v42, v43
  s_lshl_b32 s34, s61, 9
  s_add_u32 s34, s34, 122880
  v_add_u32 v38, s34, v42
  s_add_u32 s33, s33, 4
  s_and_b32 s48, s33, 1
  s_lshl_b32 s48, s48, 3
  s_lshr_b32 s33, s33, 1
  s_lshl_b32 s33, s33, 10
  s_add_u32 s33, s33, s48
  s_add_u32 s33, s33, s34
  v_add_u32 v39, s33, v43
  v_lshlrev_b32 v42, 2, v47
  v_sub_u32 v42, v42, v46
  s_or_b32 s33, s29, s61
  s_cmp_eq_u32 s33, 0
  s_cselect_b32 s33, 100, 9
  v_mov_b32 v44, 0xff61b1e6
  v_add_u32 v43, 0, v42
  v_cmp_gt_i32 vcc, s33, v43
  s_nop 1
  v_cndmask_b32 v20, 0, v44, vcc
  v_add_u32 v43, 7, v43
  v_cmp_lt_u32 vcc, 7, v43
  s_nop 1
  v_cndmask_b32 v24, 0, v44, vcc
  v_add_u32 v43, 1, v42
  v_cmp_gt_i32 vcc, s33, v43
  s_nop 1
  v_cndmask_b32 v21, 0, v44, vcc
  v_add_u32 v43, 7, v43
  v_cmp_lt_u32 vcc, 7, v43
  s_nop 1
  v_cndmask_b32 v25, 0, v44, vcc
  v_add_u32 v43, 2, v42
  v_cmp_gt_i32 vcc, s33, v43
  s_nop 1
  v_cndmask_b32 v22, 0, v44, vcc
  v_add_u32 v43, 7, v43
  v_cmp_lt_u32 vcc, 7, v43
  s_nop 1
  v_cndmask_b32 v26, 0, v44, vcc
  v_add_u32 v43, 3, v42
  v_cmp_gt_i32 vcc, s33, v43
  s_nop 1
  v_cndmask_b32 v23, 0, v44, vcc
  v_add_u32 v43, 7, v43
  v_cmp_lt_u32 vcc, 7, v43
  s_nop 1
  v_cndmask_b32 v27, 0, v44, vcc
  v_mov_b32 v102, 0
  v_mov_b32 v103, 0
  v_mov_b32 v142, 0
  v_mov_b32 v143, 0
  v_mul_u32_u24 v42, 20480, v47
  v_lshl_add_u32 v40, v46, 4, v42
  v_lshlrev_b32 v41, 4, v0
  v_add_u32 v41, 122880, v41
  s_mul_i32 s34, s29, 81920
  s_add_u32 s34, s34, 11010048
  s_mul_i32 s33, s30, 10
  s_add_u32 s33, s33, s28
  s_and_b32 s58, s33, 3
  s_lshl_b32 s58, s58, 8
  s_lshr_b32 s33, s33, 2
  s_lshl_b32 s33, s33, 10
  s_add_u32 s58, s58, s33
  s_add_u32 s58, s58, s34
  s_mul_i32 s33, s30, 10
  s_add_u32 s33, s33, s28
  s_add_u32 s33, s33, 8
  s_and_b32 s59, s33, 3
  s_lshl_b32 s59, s59, 8
  s_lshr_b32 s33, s33, 2
  s_lshl_b32 s33, s33, 10
  s_add_u32 s59, s59, s33
  s_add_u32 s59, s59, s34
  s_cmp_lt_u32 s28, 2
  s_cselect_b32 s59, s59, 0x80000000
  s_mov_b32 s62, 0x3ea52b5c
  s_waitcnt vmcnt(0) lgkmcnt(0)
  ds_read_b64 v[100:101], v34 offset:0
  ds_read_b64 v[104:105], v35 offset:0
  ds_read_b64 v[106:107], v36 offset:0
  ds_read_b64 v[108:109], v35 offset:256
  ds_read_b64 v[110:111], v36 offset:256
  s_mov_b64 exec, 0xffff
  ds_read_b64 v[102:103], v34 offset:1024
  s_mov_b64 exec, -1
  ds_read_b64 v[140:141], v34 offset:8
  ds_read_b64 v[144:145], v35 offset:8
  ds_read_b64 v[146:147], v36 offset:8
  ds_read_b64 v[148:149], v35 offset:264
  ds_read_b64 v[150:151], v36 offset:264
  s_mov_b64 exec, 0xffff
  ds_read_b64 v[142:143], v34 offset:1032
  s_mov_b64 exec, -1
  ds_read_b64_tr_b16 v[112:113], v37 offset:0
  ds_read_b64_tr_b16 v[114:115], v37 offset:256
  ds_read_b64_tr_b16 v[116:117], v37 offset:1536
  ds_read_b64_tr_b16 v[118:119], v37 offset:1792
  ds_read_b64_tr_b16 v[152:153], v37 offset:8
  ds_read_b64_tr_b16 v[154:155], v37 offset:264
  ds_read_b64_tr_b16 v[156:157], v37 offset:1544
  ds_read_b64_tr_b16 v[158:159], v37 offset:1800
  s_waitcnt lgkmcnt(14)
  v_mfma_f32_16x16x32_bf16 v[120:123], v[104:107], v[100:103], v[20:23]
  v_mfma_f32_16x16x32_bf16 v[124:127], v[108:111], v[100:103], v[24:27]
  s_waitcnt lgkmcnt(8)
  v_mfma_f32_16x16x32_bf16 v[160:163], v[144:147], v[140:143], v[20:23]
  v_mfma_f32_16x16x32_bf16 v[164:167], v[148:151], v[140:143], v[24:27]
  s_nop 3
  v_max3_f32 v28, v120, v121, v122
  v_max3_f32 v28, v28, v123, v124
  v_max3_f32 v28, v28, v125, v126
  v_max_f32 v28, v28, v127
  v_max3_f32 v31, v160, v161, v162
  v_max3_f32 v31, v31, v163, v164
  v_max3_f32 v31, v31, v165, v166
  v_max_f32 v31, v31, v167
  v_mov_b32 v29, v28
  v_mov_b32 v32, v31
  s_nop 0
  v_permlane16_swap_b32 v28, v29
  v_permlane16_swap_b32 v31, v32
  v_max_f32 v28, v28, v29
  v_max_f32 v31, v31, v32
  v_mov_b32 v29, v28
  v_mov_b32 v32, v31
  s_nop 0
  v_permlane32_swap_b32 v28, v29
  v_permlane32_swap_b32 v31, v32
  v_max_f32 v28, v28, v29
  v_max_f32 v31, v31, v32
  v_mul_f32 v28, s62, v28
  v_mul_f32 v31, s62, v31
  v_fma_f32 v120, v120, s62, -v28
  v_fma_f32 v160, v160, s62, -v31
  v_fma_f32 v121, v121, s62, -v28
  v_fma_f32 v161, v161, s62, -v31
  v_fma_f32 v122, v122, s62, -v28
  v_fma_f32 v162, v162, s62, -v31
  v_fma_f32 v123, v123, s62, -v28
  v_fma_f32 v163, v163, s62, -v31
  v_fma_f32 v124, v124, s62, -v28
  v_fma_f32 v164, v164, s62, -v31
  v_fma_f32 v125, v125, s62, -v28
  v_fma_f32 v165, v165, s62, -v31
  v_fma_f32 v126, v126, s62, -v28
  v_fma_f32 v166, v166, s62, -v31
  v_fma_f32 v127, v127, s62, -v28
  v_fma_f32 v167, v167, s62, -v31
  v_exp_f32 v120, v120
  v_exp_f32 v160, v160
  v_exp_f32 v121, v121
  v_exp_f32 v161, v161
  v_exp_f32 v122, v122
  v_exp_f32 v162, v162
  v_exp_f32 v123, v123
  v_exp_f32 v163, v163
  v_exp_f32 v124, v124
  v_exp_f32 v164, v164
  v_exp_f32 v125, v125
  v_exp_f32 v165, v165
  v_exp_f32 v126, v126
  v_exp_f32 v166, v166
  v_exp_f32 v127, v127
  v_exp_f32 v167, v167
  v_cvt_pk_bf16_f32 v128, v120, v121
  v_cvt_pk_bf16_f32 v129, v122, v123
  v_cvt_pk_bf16_f32 v130, v124, v125
  v_cvt_pk_bf16_f32 v131, v126, v127
  v_cvt_pk_bf16_f32 v168, v160, v161
  v_cvt_pk_bf16_f32 v169, v162, v163
  v_cvt_pk_bf16_f32 v170, v164, v165
  v_cvt_pk_bf16_f32 v171, v166, v167
  v_add_f32 v30, v120, v121
  v_add_f32 v30, v30, v122
  v_add_f32 v30, v30, v123
  v_add_f32 v30, v30, v124
  v_add_f32 v30, v30, v125
  v_add_f32 v30, v30, v126
  v_add_f32 v30, v30, v127
  v_add_f32 v33, v160, v161
  v_add_f32 v33, v33, v162
  v_add_f32 v33, v33, v163
  v_add_f32 v33, v33, v164
  v_add_f32 v33, v33, v165
  v_add_f32 v33, v33, v166
  v_add_f32 v33, v33, v167
  s_waitcnt lgkmcnt(0)
  v_mfma_f32_16x16x32_bf16 v[132:135], v[112:115], v[128:131], 0
  v_mfma_f32_16x16x32_bf16 v[136:139], v[116:119], v[128:131], 0
  v_mfma_f32_16x16x32_bf16 v[172:175], v[152:155], v[168:171], 0
  v_mfma_f32_16x16x32_bf16 v[176:179], v[156:159], v[168:171], 0
  v_mov_b32 v29, v30
  v_mov_b32 v32, v33
  s_nop 0
  v_permlane16_swap_b32 v30, v29
  v_permlane16_swap_b32 v33, v32
  v_add_f32 v30, v30, v29
  v_add_f32 v33, v33, v32
  v_mov_b32 v29, v30
  v_mov_b32 v32, v33
  s_nop 0
  v_permlane32_swap_b32 v30, v29
  v_permlane32_swap_b32 v33, v32
  v_add_f32 v30, v30, v29
  v_add_f32 v33, v33, v32
  v_rcp_f32 v30, v30
  v_rcp_f32 v33, v33
  v_mul_f32 v132, v132, v30
  v_mul_f32 v133, v133, v30
  v_mul_f32 v134, v134, v30
  v_mul_f32 v135, v135, v30
  v_cvt_pk_bf16_f32 v132, v132, v133
  v_cvt_pk_bf16_f32 v133, v134, v135
  v_mul_f32 v136, v136, v30
  v_mul_f32 v137, v137, v30
  v_mul_f32 v138, v138, v30
  v_mul_f32 v139, v139, v30
  v_cvt_pk_bf16_f32 v136, v136, v137
  v_cvt_pk_bf16_f32 v137, v138, v139
  v_mul_f32 v172, v172, v33
  v_mul_f32 v173, v173, v33
  v_mul_f32 v174, v174, v33
  v_mul_f32 v175, v175, v33
  v_cvt_pk_bf16_f32 v172, v172, v173
  v_cvt_pk_bf16_f32 v173, v174, v175
  v_mul_f32 v176, v176, v33
  v_mul_f32 v177, v177, v33
  v_mul_f32 v178, v178, v33
  v_mul_f32 v179, v179, v33
  v_cvt_pk_bf16_f32 v176, v176, v177
  v_cvt_pk_bf16_f32 v177, v178, v179
  ds_write_b64 v38, v[132:133] offset:0
  ds_write_b64 v38, v[172:173] offset:16
  s_mov_b64 exec, 0xffff
  ds_write_b64 v39, v[136:137] offset:0
  ds_write_b64 v39, v[176:177] offset:16
  s_mov_b64 exec, -1
  s_waitcnt lgkmcnt(0)
  s_barrier
  ds_read_b128 v[20:23], v41
  ds_read_b128 v[24:27], v41 offset:8192
  s_waitcnt lgkmcnt(0)
  buffer_store_dwordx4 v[20:23], v40, s[8:11], s58 offen sc1
  buffer_store_dwordx4 v[24:27], v40, s[8:11], s59 offen sc1
  s_barrier
  s_barrier
  v_and_b32 v56, 7, v0
  v_lshlrev_b32 v56, 3, v56
  v_and_b32 v80, 63, v0
  v_lshlrev_b32 v1, 4, v80
  v_lshrrev_b32 v81, 5, v80
  v_lshlrev_b32 v81, 4, v81
  v_lshrrev_b32 v82, 4, v80
  v_and_b32 v82, 1, v82
  v_lshlrev_b32 v82, 2, v82
  v_add_u32 v81, v81, v82
  v_lshrrev_b32 v82, 2, v80
  v_and_b32 v82, 3, v82
  v_add_u32 v81, v81, v82
  v_mul_u32_u24 v81, 160, v81
  v_and_b32 v82, 3, v80
  v_lshlrev_b32 v82, 3, v82
  v_add_u32 v81, v81, v82
  v_mov_b32 v81, v1
  s_mul_i32 s33, s41, 5120
  s_add_u32 s33, s33, 0
  v_add_u32 v2, s33, v81
  v_add_u32 v3, 0x10000, v2
  v_add_u32 v4, 0x20000, v2
  s_lshl_b32 s33, s29, 6
  s_mul_i32 s33, s33, 1280
  s_mul_i32 s34, s30, 160
  s_add_u32 s33, s33, s34
  v_and_b32 v81, 15, v80
  v_lshrrev_b32 v82, 4, v80
  s_lshl_b32 s33, s29, 6
  s_lshl_b32 s34, s42, 4
  s_add_u32 s33, s33, s34
  s_mul_i32 s33, s33, 1280
  s_mul_i32 s34, s30, 160
  s_add_u32 s33, s33, s34
  v_mul_u32_u24 v81, 1280, v81
  v_add_u32 v81, s33, v81
  v_lshl_add_u32 v7, v82, 3, v81
  s_and_b32 s34, s30, 1
  s_cmp_eq_u32 s34, 0
  s_cselect_b32 s33, 128, 0
  v_add_u32 v7, s33, v7
  s_cmp_eq_u32 s41, 0
  s_cselect_b32 s33, 0, 0x80000000
  v_or_b32 v7, s33, v7
  v_and_b32 v83, 1, v82
  v_lshl_add_u32 v81, v83, 5, v81
  v_lshrrev_b32 v83, 1, v82
  v_lshl_add_u32 v81, v83, 4, v81
  s_lshl_b32 s33, s41, 6
  s_lshl_b32 s34, s34, 5
  s_add_u32 s33, s33, s34
  v_add_u32 v6, s33, v81
  s_mul_i32 s33, s42, 5120
  v_add_u32 v8, s33, v1
  s_mul_i32 s43, s30, 240640
  s_mul_i32 s33, s28, 1024
  s_add_u32 s43, s43, s33
  s_add_u32 s43, s43, 25304064
  s_add_u32 s46, s33, 0
  s_lshl_b32 s33, s29, 2
  s_add_u32 s33, s33, s42
  s_mul_i32 s44, s33, 27648
  s_lshl_b32 s34, s41, 10
  s_add_u32 s44, s44, s34
  s_add_u32 s44, s44, 7340032
  s_mul_i32 s45, s33, 20480
  s_add_u32 s45, s45, s34
  s_add_u32 s45, s45, 11010048
  s_barrier
  s_waitcnt vmcnt(0)
  s_barrier
  s_barrier
  s_barrier
  s_barrier
  s_barrier
  s_barrier
  s_barrier
  s_barrier
  s_barrier
  s_add_u32 m0, s46, 81920
  s_nop 0
  buffer_load_dwordx4 v1, s[8:11], s43 offen lds
  s_add_u32 s43, s43, 8192
  s_add_u32 m0, s46, 90112
  s_nop 0
  buffer_load_dwordx4 v1, s[8:11], s43 offen lds
  s_add_u32 s43, s43, 8192
  buffer_load_dwordx4 v[20:23], v1, s[8:11], s45 offen
  s_add_u32 s45, s45, 2048
  s_barrier
  s_add_u32 m0, s46, 98304
  s_nop 0
  buffer_load_dwordx4 v1, s[8:11], s43 offen lds
  s_add_u32 s43, s43, 8192
  buffer_load_dwordx4 v[24:27], v1, s[8:11], s45 offen
  s_add_u32 s45, s45, 2048
  s_add_u32 m0, s46, 106496
  s_nop 0
  buffer_load_dwordx4 v1, s[8:11], s43 offen lds
  s_add_u32 s43, s43, 8192
  buffer_load_dwordx4 v[28:31], v1, s[8:11], s45 offen
  s_add_u32 s45, s45, 2048
  s_add_u32 m0, s46, 114688
  s_nop 0
  buffer_load_dwordx4 v1, s[8:11], s43 offen lds
  s_add_u32 s43, s43, 8192
  buffer_load_dwordx4 v[32:35], v1, s[8:11], s45 offen
  s_add_u32 s45, s45, 2048
  s_barrier
  s_add_u32 m0, s46, 122880
  s_nop 0
  buffer_load_dwordx4 v1, s[8:11], s43 offen lds
  s_add_u32 s43, s43, 8192
  s_add_u32 m0, s46, 131072
  s_nop 0
  buffer_load_dwordx4 v1, s[8:11], s43 offen lds
  s_add_u32 s43, s43, 8192
  buffer_load_dwordx4 v[36:39], v1, s[8:11], s45 offen
  s_add_u32 s45, s45, 2048
  s_add_u32 m0, s46, 139264
  s_nop 0
  buffer_load_dwordx4 v1, s[8:11], s43 offen lds
  s_add_u32 s43, s43, 8192
  buffer_load_dwordx4 v[40:43], v1, s[8:11], s45 offen
  s_add_u32 s45, s45, 2048
  s_barrier
  s_add_u32 m0, s46, 147456
  s_nop 0
  buffer_load_dwordx4 v1, s[8:11], s43 offen lds
  s_add_u32 s43, s43, 8192
  buffer_load_dwordx4 v[44:47], v1, s[8:11], s45 offen
  s_add_u32 s45, s45, 2048
  s_add_u32 m0, s46, 155648
  s_nop 0
  buffer_load_dwordx4 v1, s[8:11], s43 offen lds
  s_add_u32 s43, s43, 8192
  buffer_load_dwordx4 v[48:51], v1, s[8:11], s45 offen
  s_add_u32 s45, s45, 2048
  s_branch K2_p3
K2_loader:
  v_and_b32 v99, 63, v0
  v_lshrrev_b32 v58, 4, v99
  v_and_b32 v60, 7, v99
  v_xor_b32 v59, v58, v60
  v_lshlrev_b32 v59, 4, v59
  v_lshrrev_b32 v60, 3, v99
  v_lshlrev_b32 v60, 12, v60
  v_add_u32 v62, v59, v60
  v_xor_b32 v64, 64, v62
  v_add_u32 v64, 0x8000, v64
  s_lshl_b32 s33, s29, 18
  s_add_u32 s4, s4, s33
  s_addc_u32 s5, s5, 0
  s_mov_b32 s6, 0x40000
  s_mov_b32 s7, 0x00020000
  s_mov_b32 s38, 0
  s_mov_b32 s39, 65536
  s_mov_b32 s40, 131072
  s_mov_b32 s35, 196608
  s_mov_b32 m0, 0
  s_nop 0
  buffer_load_dwordx4 v62, s[4:7], s38 offen lds
  s_mov_b32 m0, 1024
  s_nop 0
  buffer_load_dwordx4 v64, s[4:7], s38 offen lds
  s_mov_b32 m0, 2048
  s_nop 0
  buffer_load_dwordx4 v62, s[4:7], s39 offen lds
  s_mov_b32 m0, 3072
  s_nop 0
  buffer_load_dwordx4 v64, s[4:7], s39 offen lds
  s_mov_b32 m0, 4096
  s_nop 0
  buffer_load_dwordx4 v62, s[4:7], s40 offen lds
  s_mov_b32 m0, 5120
  s_nop 0
  buffer_load_dwordx4 v64, s[4:7], s40 offen lds
  s_mov_b32 m0, 6144
  s_nop 0
  buffer_load_dwordx4 v62, s[4:7], s35 offen lds
  s_mov_b32 m0, 7168
  s_nop 0
  buffer_load_dwordx4 v64, s[4:7], s35 offen lds
  s_add_u32 s38, s38, 128
  s_add_u32 s39, s39, 128
  s_add_u32 s40, s40, 128
  s_add_u32 s35, s35, 128
  s_mov_b32 m0, 8192
  s_nop 0
  buffer_load_dwordx4 v62, s[4:7], s38 offen lds
  s_mov_b32 m0, 9216
  s_nop 0
  buffer_load_dwordx4 v64, s[4:7], s38 offen lds
  s_mov_b32 m0, 10240
  s_nop 0
  buffer_load_dwordx4 v62, s[4:7], s39 offen lds
  s_mov_b32 m0, 11264
  s_nop 0
  buffer_load_dwordx4 v64, s[4:7], s39 offen lds
  s_mov_b32 m0, 12288
  s_nop 0
  buffer_load_dwordx4 v62, s[4:7], s40 offen lds
  s_mov_b32 m0, 13312
  s_nop 0
  buffer_load_dwordx4 v64, s[4:7], s40 offen lds
  s_mov_b32 m0, 14336
  s_nop 0
  buffer_load_dwordx4 v62, s[4:7], s35 offen lds
  s_mov_b32 m0, 15360
  s_nop 0
  buffer_load_dwordx4 v64, s[4:7], s35 offen lds
  s_add_u32 s38, s38, 128
  s_add_u32 s39, s39, 128
  s_add_u32 s40, s40, 128
  s_add_u32 s35, s35, 128
  v_and_b32 v45, 63, v0
  v_and_b32 v46, 15, v45
  v_lshrrev_b32 v47, 4, v45
  v_lshlrev_b32 v43, 4, v46
  v_lshl_add_u32 v42, v47, 8, v43
  v_add_u32 v34, s57, v42
  s_add_u32 s33, s57, 1152
  v_mul_u32_u24 v42, 384, v47
  v_add_u32 v42, v42, v43
  v_add_u32 v35, s33, v42
  s_add_u32 s33, s33, 1536
  v_add_u32 v36, s33, v43
  s_add_u32 s33, s57, 3072
  v_and_b32 v42, 3, v45
  v_mul_u32_u24 v42, 384, v42
  v_lshrrev_b32 v43, 2, v45
  v_lshl_add_u32 v42, v43, 4, v42
  v_add_u32 v37, s33, v42
  s_mul_i32 s33, s60, 5
  v_add_u32 v42, s33, v47
  v_lshrrev_b32 v43, 1, v42
  v_lshlrev_b32 v43, 10, v43
  v_and_b32 v42, 1, v42
  v_lshl_add_u32 v42, v42, 3, v43
  v_lshlrev_b32 v43, 5, v46
  v_add_u32 v42, v42, v43
  s_lshl_b32 s34, s61, 9
  s_add_u32 s34, s34, 122880
  v_add_u32 v38, s34, v42
  s_add_u32 s33, s33, 4
  s_and_b32 s48, s33, 1
  s_lshl_b32 s48, s48, 3
  s_lshr_b32 s33, s33, 1
  s_lshl_b32 s33, s33, 10
  s_add_u32 s33, s33, s48
  s_add_u32 s33, s33, s34
  v_add_u32 v39, s33, v43
  v_lshlrev_b32 v42, 2, v47
  v_sub_u32 v42, v42, v46
  s_or_b32 s33, s29, s61
  s_cmp_eq_u32 s33, 0
  s_cselect_b32 s33, 100, 9
  v_mov_b32 v44, 0xff61b1e6
  v_add_u32 v43, 0, v42
  v_cmp_gt_i32 vcc, s33, v43
  s_nop 1
  v_cndmask_b32 v20, 0, v44, vcc
  v_add_u32 v43, 7, v43
  v_cmp_lt_u32 vcc, 7, v43
  s_nop 1
  v_cndmask_b32 v24, 0, v44, vcc
  v_add_u32 v43, 1, v42
  v_cmp_gt_i32 vcc, s33, v43
  s_nop 1
  v_cndmask_b32 v21, 0, v44, vcc
  v_add_u32 v43, 7, v43
  v_cmp_lt_u32 vcc, 7, v43
  s_nop 1
  v_cndmask_b32 v25, 0, v44, vcc
  v_add_u32 v43, 2, v42
  v_cmp_gt_i32 vcc, s33, v43
  s_nop 1
  v_cndmask_b32 v22, 0, v44, vcc
  v_add_u32 v43, 7, v43
  v_cmp_lt_u32 vcc, 7, v43
  s_nop 1
  v_cndmask_b32 v26, 0, v44, vcc
  v_add_u32 v43, 3, v42
  v_cmp_gt_i32 vcc, s33, v43
  s_nop 1
  v_cndmask_b32 v23, 0, v44, vcc
  v_add_u32 v43, 7, v43
  v_cmp_lt_u32 vcc, 7, v43
  s_nop 1
  v_cndmask_b32 v27, 0, v44, vcc
  v_mov_b32 v102, 0
  v_mov_b32 v103, 0
  v_mov_b32 v142, 0
  v_mov_b32 v143, 0
  v_mul_u32_u24 v42, 20480, v47
  v_lshl_add_u32 v40, v46, 4, v42
  v_lshlrev_b32 v41, 4, v0
  v_add_u32 v41, 122880, v41
  s_mul_i32 s34, s29, 81920
  s_add_u32 s34, s34, 11010048
  s_mul_i32 s33, s30, 10
  s_add_u32 s33, s33, s28
  s_and_b32 s58, s33, 3
  s_lshl_b32 s58, s58, 8
  s_lshr_b32 s33, s33, 2
  s_lshl_b32 s33, s33, 10
  s_add_u32 s58, s58, s33
  s_add_u32 s58, s58, s34
  s_mul_i32 s33, s30, 10
  s_add_u32 s33, s33, s28
  s_add_u32 s33, s33, 8
  s_and_b32 s59, s33, 3
  s_lshl_b32 s59, s59, 8
  s_lshr_b32 s33, s33, 2
  s_lshl_b32 s33, s33, 10
  s_add_u32 s59, s59, s33
  s_add_u32 s59, s59, s34
  s_cmp_lt_u32 s28, 2
  s_cselect_b32 s59, s59, 0x80000000
  s_mov_b32 s62, 0x3ea52b5c
  s_waitcnt vmcnt(16) lgkmcnt(0)
  ds_read_b64 v[100:101], v34 offset:0
  ds_read_b64 v[104:105], v35 offset:0
  ds_read_b64 v[106:107], v36 offset:0
  ds_read_b64 v[108:109], v35 offset:256
  ds_read_b64 v[110:111], v36 offset:256
  s_mov_b64 exec, 0xffff
  ds_read_b64 v[102:103], v34 offset:1024
  s_mov_b64 exec, -1
  ds_read_b64 v[140:141], v34 offset:8
  ds_read_b64 v[144:145], v35 offset:8
  ds_read_b64 v[146:147], v36 offset:8
  ds_read_b64 v[148:149], v35 offset:264
  ds_read_b64 v[150:151], v36 offset:264
  s_mov_b64 exec, 0xffff
  ds_read_b64 v[142:143], v34 offset:1032
  s_mov_b64 exec, -1
  ds_read_b64_tr_b16 v[112:113], v37 offset:0
  s_mov_b32 m0, 16384
  s_nop 0
  buffer_load_dwordx4 v62, s[4:7], s38 offen lds
  ds_read_b64_tr_b16 v[114:115], v37 offset:256
  ds_read_b64_tr_b16 v[116:117], v37 offset:1536
  ds_read_b64_tr_b16 v[118:119], v37 offset:1792
  ds_read_b64_tr_b16 v[152:153], v37 offset:8
  ds_read_b64_tr_b16 v[154:155], v37 offset:264
  ds_read_b64_tr_b16 v[156:157], v37 offset:1544
  ds_read_b64_tr_b16 v[158:159], v37 offset:1800
  s_waitcnt lgkmcnt(14)
  v_mfma_f32_16x16x32_bf16 v[120:123], v[104:107], v[100:103], v[20:23]
  v_mfma_f32_16x16x32_bf16 v[124:127], v[108:111], v[100:103], v[24:27]
  s_mov_b32 m0, 17408
  s_nop 0
  buffer_load_dwordx4 v64, s[4:7], s38 offen lds
  s_waitcnt lgkmcnt(8)
  v_mfma_f32_16x16x32_bf16 v[160:163], v[144:147], v[140:143], v[20:23]
  v_mfma_f32_16x16x32_bf16 v[164:167], v[148:151], v[140:143], v[24:27]
  s_nop 0
  v_max3_f32 v28, v120, v121, v122
  v_max3_f32 v28, v28, v123, v124
  v_max3_f32 v28, v28, v125, v126
  v_max_f32 v28, v28, v127
  s_nop 1
  v_max3_f32 v31, v160, v161, v162
  v_max3_f32 v31, v31, v163, v164
  v_max3_f32 v31, v31, v165, v166
  s_mov_b32 m0, 18432
  s_nop 0
  buffer_load_dwordx4 v62, s[4:7], s39 offen lds
  v_max_f32 v31, v31, v167
  v_mov_b32 v29, v28
  v_mov_b32 v32, v31
  s_nop 0
  v_permlane16_swap_b32 v28, v29
  v_permlane16_swap_b32 v31, v32
  v_max_f32 v28, v28, v29
  v_max_f32 v31, v31, v32
  v_mov_b32 v29, v28
  v_mov_b32 v32, v31
  s_nop 0
  v_permlane32_swap_b32 v28, v29
  s_mov_b32 m0, 19456
  s_nop 0
  buffer_load_dwordx4 v64, s[4:7], s39 offen lds
  v_permlane32_swap_b32 v31, v32
  v_max_f32 v28, v28, v29
  v_max_f32 v31, v31, v32
  v_mul_f32 v28, s62, v28
  v_mul_f32 v31, s62, v31
  v_fma_f32 v120, v120, s62, -v28
  v_fma_f32 v160, v160, s62, -v31
  v_fma_f32 v121, v121, s62, -v28
  v_fma_f32 v161, v161, s62, -v31
  v_fma_f32 v122, v122, s62, -v28
  s_mov_b32 m0, 20480
  s_nop 0
  buffer_load_dwordx4 v62, s[4:7], s40 offen lds
  v_fma_f32 v162, v162, s62, -v31
  v_fma_f32 v123, v123, s62, -v28
  v_fma_f32 v163, v163, s62, -v31
  v_fma_f32 v124, v124, s62, -v28
  v_fma_f32 v164, v164, s62, -v31
  v_fma_f32 v125, v125, s62, -v28
  v_fma_f32 v165, v165, s62, -v31
  v_fma_f32 v126, v126, s62, -v28
  v_fma_f32 v166, v166, s62, -v31
  v_fma_f32 v127, v127, s62, -v28
  s_mov_b32 m0, 21504
  s_nop 0
  buffer_load_dwordx4 v64, s[4:7], s40 offen lds
  v_fma_f32 v167, v167, s62, -v31
  v_exp_f32 v120, v120
  v_exp_f32 v160, v160
  v_exp_f32 v121, v121
  v_exp_f32 v161, v161
  v_exp_f32 v122, v122
  v_exp_f32 v162, v162
  v_exp_f32 v123, v123
  v_exp_f32 v163, v163
  v_exp_f32 v124, v124
  s_mov_b32 m0, 22528
  s_nop 0
  buffer_load_dwordx4 v62, s[4:7], s35 offen lds
  v_exp_f32 v164, v164
  v_exp_f32 v125, v125
  v_exp_f32 v165, v165
  v_exp_f32 v126, v126
  v_exp_f32 v166, v166
  v_exp_f32 v127, v127
  v_exp_f32 v167, v167
  v_cvt_pk_bf16_f32 v128, v120, v121
  v_cvt_pk_bf16_f32 v129, v122, v123
  v_cvt_pk_bf16_f32 v130, v124, v125
  s_mov_b32 m0, 23552
  s_nop 0
  buffer_load_dwordx4 v64, s[4:7], s35 offen lds
  s_add_u32 s38, s38, 128
  s_add_u32 s39, s39, 128
  s_add_u32 s40, s40, 128
  s_add_u32 s35, s35, 128
  v_cvt_pk_bf16_f32 v131, v126, v127
  v_cvt_pk_bf16_f32 v168, v160, v161
  v_cvt_pk_bf16_f32 v169, v162, v163
  v_cvt_pk_bf16_f32 v170, v164, v165
  v_cvt_pk_bf16_f32 v171, v166, v167
  v_add_f32 v30, v120, v121
  v_add_f32 v30, v30, v122
  v_add_f32 v30, v30, v123
  v_add_f32 v30, v30, v124
  v_add_f32 v30, v30, v125
  s_mov_b32 m0, 24576
  s_nop 0
  buffer_load_dwordx4 v62, s[4:7], s38 offen lds
  v_add_f32 v30, v30, v126
  v_add_f32 v30, v30, v127
  v_add_f32 v33, v160, v161
  v_add_f32 v33, v33, v162
  v_add_f32 v33, v33, v163
  v_add_f32 v33, v33, v164
  v_add_f32 v33, v33, v165
  v_add_f32 v33, v33, v166
  v_add_f32 v33, v33, v167
  s_waitcnt lgkmcnt(0)
  s_mov_b32 m0, 25600
  s_nop 0
  buffer_load_dwordx4 v64, s[4:7], s38 offen lds
  v_mfma_f32_16x16x32_bf16 v[132:135], v[112:115], v[128:131], 0
  v_mfma_f32_16x16x32_bf16 v[136:139], v[116:119], v[128:131], 0
  v_mfma_f32_16x16x32_bf16 v[172:175], v[152:155], v[168:171], 0
  v_mfma_f32_16x16x32_bf16 v[176:179], v[156:159], v[168:171], 0
  v_mov_b32 v29, v30
  v_mov_b32 v32, v33
  s_nop 0
  v_permlane16_swap_b32 v30, v29
  v_permlane16_swap_b32 v33, v32
  v_add_f32 v30, v30, v29
  v_add_f32 v33, v33, v32
  s_mov_b32 m0, 26624
  s_nop 0
  buffer_load_dwordx4 v62, s[4:7], s39 offen lds
  v_mov_b32 v29, v30
  v_mov_b32 v32, v33
  s_nop 0
  v_permlane32_swap_b32 v30, v29
  v_permlane32_swap_b32 v33, v32
  v_add_f32 v30, v30, v29
  v_add_f32 v33, v33, v32
  v_rcp_f32 v30, v30
  v_rcp_f32 v33, v33
  v_mul_f32 v132, v132, v30
  v_mul_f32 v133, v133, v30
  s_mov_b32 m0, 27648
  s_nop 0
  buffer_load_dwordx4 v64, s[4:7], s39 offen lds
  v_mul_f32 v134, v134, v30
  v_mul_f32 v135, v135, v30
  v_cvt_pk_bf16_f32 v132, v132, v133
  v_cvt_pk_bf16_f32 v133, v134, v135
  v_mul_f32 v136, v136, v30
  v_mul_f32 v137, v137, v30
  v_mul_f32 v138, v138, v30
  v_mul_f32 v139, v139, v30
  v_cvt_pk_bf16_f32 v136, v136, v137
  v_cvt_pk_bf16_f32 v137, v138, v139
  s_mov_b32 m0, 28672
  s_nop 0
  buffer_load_dwordx4 v62, s[4:7], s40 offen lds
  v_mul_f32 v172, v172, v33
  v_mul_f32 v173, v173, v33
  v_mul_f32 v174, v174, v33
  v_mul_f32 v175, v175, v33
  v_cvt_pk_bf16_f32 v172, v172, v173
  v_cvt_pk_bf16_f32 v173, v174, v175
  v_mul_f32 v176, v176, v33
  v_mul_f32 v177, v177, v33
  v_mul_f32 v178, v178, v33
  v_mul_f32 v179, v179, v33
  s_mov_b32 m0, 29696
  s_nop 0
  buffer_load_dwordx4 v64, s[4:7], s40 offen lds
  v_cvt_pk_bf16_f32 v176, v176, v177
  v_cvt_pk_bf16_f32 v177, v178, v179
  ds_write_b64 v38, v[132:133] offset:0
  ds_write_b64 v38, v[172:173] offset:16
  s_mov_b64 exec, 0xffff
  ds_write_b64 v39, v[136:137] offset:0
  ds_write_b64 v39, v[176:177] offset:16
  s_mov_b64 exec, -1
  s_mov_b32 m0, 30720
  s_nop 0
  buffer_load_dwordx4 v62, s[4:7], s35 offen lds
  s_mov_b32 m0, 31744
  s_nop 0
  buffer_load_dwordx4 v64, s[4:7], s35 offen lds
  s_add_u32 s38, s38, 128
  s_add_u32 s39, s39, 128
  s_add_u32 s40, s40, 128
  s_add_u32 s35, s35, 128
  s_waitcnt lgkmcnt(0)
  s_waitcnt vmcnt(16)
  s_barrier
  ds_read_b128 v[20:23], v41
  ds_read_b128 v[24:27], v41 offset:8192
  s_waitcnt lgkmcnt(0)
  buffer_store_dwordx4 v[20:23], v40, s[8:11], s58 offen sc1
  buffer_store_dwordx4 v[24:27], v40, s[8:11], s59 offen sc1
  s_mov_b32 m0, 32768
  s_nop 0
  buffer_load_dwordx4 v62, s[4:7], s38 offen lds
  s_mov_b32 m0, 33792
  s_nop 0
  buffer_load_dwordx4 v64, s[4:7], s38 offen lds
  s_mov_b32 m0, 34816
  s_nop 0
  buffer_load_dwordx4 v62, s[4:7], s39 offen lds
  s_mov_b32 m0, 35840
  s_nop 0
  buffer_load_dwordx4 v64, s[4:7], s39 offen lds
  s_mov_b32 m0, 36864
  s_nop 0
  buffer_load_dwordx4 v62, s[4:7], s40 offen lds
  s_mov_b32 m0, 37888
  s_nop 0
  buffer_load_dwordx4 v64, s[4:7], s40 offen lds
  s_mov_b32 m0, 38912
  s_nop 0
  buffer_load_dwordx4 v62, s[4:7], s35 offen lds
  s_mov_b32 m0, 39936
  s_nop 0
  buffer_load_dwordx4 v64, s[4:7], s35 offen lds
  s_add_u32 s38, s38, 128
  s_add_u32 s39, s39, 128
  s_add_u32 s40, s40, 128
  s_add_u32 s35, s35, 128
  s_mov_b32 m0, 40960
  s_nop 0
  buffer_load_dwordx4 v62, s[4:7], s38 offen lds
  s_mov_b32 m0, 41984
  s_nop 0
  buffer_load_dwordx4 v64, s[4:7], s38 offen lds
  s_mov_b32 m0, 43008
  s_nop 0
  buffer_load_dwordx4 v62, s[4:7], s39 offen lds
  s_mov_b32 m0, 44032
  s_nop 0
  buffer_load_dwordx4 v64, s[4:7], s39 offen lds
  s_mov_b32 m0, 45056
  s_nop 0
  buffer_load_dwordx4 v62, s[4:7], s40 offen lds
  s_mov_b32 m0, 46080
  s_nop 0
  buffer_load_dwordx4 v64, s[4:7], s40 offen lds
  s_mov_b32 m0, 47104
  s_nop 0
  buffer_load_dwordx4 v62, s[4:7], s35 offen lds
  s_mov_b32 m0, 48128
  s_nop 0
  buffer_load_dwordx4 v64, s[4:7], s35 offen lds
  s_add_u32 s38, s38, 128
  s_add_u32 s39, s39, 128
  s_add_u32 s40, s40, 128
  s_add_u32 s35, s35, 128
  s_mov_b32 m0, 49152
  s_nop 0
  buffer_load_dwordx4 v62, s[4:7], s38 offen lds
  s_mov_b32 m0, 50176
  s_nop 0
  buffer_load_dwordx4 v64, s[4:7], s38 offen lds
  s_mov_b32 m0, 51200
  s_nop 0
  buffer_load_dwordx4 v62, s[4:7], s39 offen lds
  s_mov_b32 m0, 52224
  s_nop 0
  buffer_load_dwordx4 v64, s[4:7], s39 offen lds
  s_mov_b32 m0, 53248
  s_nop 0
  buffer_load_dwordx4 v62, s[4:7], s40 offen lds
  s_mov_b32 m0, 54272
  s_nop 0
  buffer_load_dwordx4 v64, s[4:7], s40 offen lds
  s_mov_b32 m0, 55296
  s_nop 0
  buffer_load_dwordx4 v62, s[4:7], s35 offen lds
  s_mov_b32 m0, 56320
  s_nop 0
  buffer_load_dwordx4 v64, s[4:7], s35 offen lds
  s_add_u32 s38, s38, 128
  s_add_u32 s39, s39, 128
  s_add_u32 s40, s40, 128
  s_add_u32 s35, s35, 128
  s_mov_b32 m0, 57344
  s_nop 0
  buffer_load_dwordx4 v62, s[4:7], s38 offen lds
  s_mov_b32 m0, 58368
  s_nop 0
  buffer_load_dwordx4 v64, s[4:7], s38 offen lds
  s_mov_b32 m0, 59392
  s_nop 0
  buffer_load_dwordx4 v62, s[4:7], s39 offen lds
  s_mov_b32 m0, 60416
  s_nop 0
  buffer_load_dwordx4 v64, s[4:7], s39 offen lds
  s_mov_b32 m0, 61440
  s_nop 0
  buffer_load_dwordx4 v62, s[4:7], s40 offen lds
  s_mov_b32 m0, 62464
  s_nop 0
  buffer_load_dwordx4 v64, s[4:7], s40 offen lds
  s_mov_b32 m0, 63488
  s_nop 0
  buffer_load_dwordx4 v62, s[4:7], s35 offen lds
  s_mov_b32 m0, 64512
  s_nop 0
  buffer_load_dwordx4 v64, s[4:7], s35 offen lds
  s_add_u32 s38, s38, 128
  s_add_u32 s39, s39, 128
  s_add_u32 s40, s40, 128
  s_add_u32 s35, s35, 128
  s_waitcnt vmcnt(34)
  s_barrier
  s_mov_b32 m0, 65536
  s_nop 0
  buffer_load_dwordx4 v62, s[4:7], s38 offen lds
  s_mov_b32 m0, 66560
  s_nop 0
  buffer_load_dwordx4 v64, s[4:7], s38 offen lds
  s_mov_b32 m0, 67584
  s_nop 0
  buffer_load_dwordx4 v62, s[4:7], s39 offen lds
  s_mov_b32 m0, 68608
  s_nop 0
  buffer_load_dwordx4 v64, s[4:7], s39 offen lds
  s_mov_b32 m0, 69632
  s_nop 0
  buffer_load_dwordx4 v62, s[4:7], s40 offen lds
  s_mov_b32 m0, 70656
  s_nop 0
  buffer_load_dwordx4 v64, s[4:7], s40 offen lds
  s_mov_b32 m0, 71680
  s_nop 0
  buffer_load_dwordx4 v62, s[4:7], s35 offen lds
  s_mov_b32 m0, 72704
  s_nop 0
  buffer_load_dwordx4 v64, s[4:7], s35 offen lds
  s_add_u32 s38, s38, 128
  s_add_u32 s39, s39, 128
  s_add_u32 s40, s40, 128
  s_add_u32 s35, s35, 128
  s_mov_b32 m0, 73728
  s_nop 0
  buffer_load_dwordx4 v62, s[4:7], s38 offen lds
  s_mov_b32 m0, 74752
  s_nop 0
  buffer_load_dwordx4 v64, s[4:7], s38 offen lds
  s_mov_b32 m0, 75776
  s_nop 0
  buffer_load_dwordx4 v62, s[4:7], s39 offen lds
  s_mov_b32 m0, 76800
  s_nop 0
  buffer_load_dwordx4 v64, s[4:7], s39 offen lds
  s_mov_b32 m0, 77824
  s_nop 0
  buffer_load_dwordx4 v62, s[4:7], s40 offen lds
  s_mov_b32 m0, 78848
  s_nop 0
  buffer_load_dwordx4 v64, s[4:7], s40 offen lds
  s_mov_b32 m0, 79872
  s_nop 0
  buffer_load_dwordx4 v62, s[4:7], s35 offen lds
  s_mov_b32 m0, 80896
  s_nop 0
  buffer_load_dwordx4 v64, s[4:7], s35 offen lds
  s_add_u32 s38, s38, 128
  s_add_u32 s39, s39, 128
  s_add_u32 s40, s40, 128
  s_add_u32 s35, s35, 128
  s_mov_b32 m0, 0
  s_nop 0
  buffer_load_dwordx4 v62, s[4:7], s38 offen lds
  s_mov_b32 m0, 1024
  s_nop 0
  buffer_load_dwordx4 v64, s[4:7], s38 offen lds
  s_mov_b32 m0, 2048
  s_nop 0
  buffer_load_dwordx4 v62, s[4:7], s39 offen lds
  s_mov_b32 m0, 3072
  s_nop 0
  buffer_load_dwordx4 v64, s[4:7], s39 offen lds
  s_mov_b32 m0, 4096
  s_nop 0
  buffer_load_dwordx4 v62, s[4:7], s40 offen lds
  s_mov_b32 m0, 5120
  s_nop 0
  buffer_load_dwordx4 v64, s[4:7], s40 offen lds
  s_mov_b32 m0, 6144
  s_nop 0
  buffer_load_dwordx4 v62, s[4:7], s35 offen lds
  s_mov_b32 m0, 7168
  s_nop 0
  buffer_load_dwordx4 v64, s[4:7], s35 offen lds
  s_add_u32 s38, s38, 128
  s_add_u32 s39, s39, 128
  s_add_u32 s40, s40, 128
  s_add_u32 s35, s35, 128
  s_waitcnt vmcnt(40)
  s_barrier
  s_mov_b32 m0, 8192
  s_nop 0
  buffer_load_dwordx4 v62, s[4:7], s38 offen lds
  s_mov_b32 m0, 9216
  s_nop 0
  buffer_load_dwordx4 v64, s[4:7], s38 offen lds
  s_mov_b32 m0, 10240
  s_nop 0
  buffer_load_dwordx4 v62, s[4:7], s39 offen lds
  s_mov_b32 m0, 11264
  s_nop 0
  buffer_load_dwordx4 v64, s[4:7], s39 offen lds
  s_mov_b32 m0, 12288
  s_nop 0
  buffer_load_dwordx4 v62, s[4:7], s40 offen lds
  s_mov_b32 m0, 13312
  s_nop 0
  buffer_load_dwordx4 v64, s[4:7], s40 offen lds
  s_mov_b32 m0, 14336
  s_nop 0
  buffer_load_dwordx4 v62, s[4:7], s35 offen lds
  s_mov_b32 m0, 15360
  s_nop 0
  buffer_load_dwordx4 v64, s[4:7], s35 offen lds
  s_add_u32 s38, s38, 128
  s_add_u32 s39, s39, 128
  s_add_u32 s40, s40, 128
  s_add_u32 s35, s35, 128
  s_mov_b32 m0, 16384
  s_nop 0
  buffer_load_dwordx4 v62, s[4:7], s38 offen lds
  s_mov_b32 m0, 17408
  s_nop 0
  buffer_load_dwordx4 v64, s[4:7], s38 offen lds
  s_mov_b32 m0, 18432
  s_nop 0
  buffer_load_dwordx4 v62, s[4:7], s39 offen lds
  s_mov_b32 m0, 19456
  s_nop 0
  buffer_load_dwordx4 v64, s[4:7], s39 offen lds
  s_mov_b32 m0, 20480
  s_nop 0
  buffer_load_dwordx4 v62, s[4:7], s40 offen lds
  s_mov_b32 m0, 21504
  s_nop 0
  buffer_load_dwordx4 v64, s[4:7], s40 offen lds
  s_mov_b32 m0, 22528
  s_nop 0
  buffer_load_dwordx4 v62, s[4:7], s35 offen lds
  s_mov_b32 m0, 23552
  s_nop 0
  buffer_load_dwordx4 v64, s[4:7], s35 offen lds
  s_add_u32 s38, s38, 128
  s_add_u32 s39, s39, 128
  s_add_u32 s40, s40, 128
  s_add_u32 s35, s35, 128
  v_and_b32 v56, 7, v0
  v_lshlrev_b32 v56, 3, v56
  v_and_b32 v80, 63, v0
  v_lshlrev_b32 v1, 4, v80
  v_lshrrev_b32 v81, 5, v80
  v_lshlrev_b32 v81, 4, v81
  v_lshrrev_b32 v82, 4, v80
  v_and_b32 v82, 1, v82
  v_lshlrev_b32 v82, 2, v82
  v_add_u32 v81, v81, v82
  v_lshrrev_b32 v82, 2, v80
  v_and_b32 v82, 3, v82
  v_add_u32 v81, v81, v82
  v_mul_u32_u24 v81, 160, v81
  v_and_b32 v82, 3, v80
  v_lshlrev_b32 v82, 3, v82
  v_add_u32 v81, v81, v82
  v_mov_b32 v81, v1
  s_mul_i32 s33, s41, 5120
  s_add_u32 s33, s33, 0
  v_add_u32 v2, s33, v81
  v_add_u32 v3, 0x10000, v2
  v_add_u32 v4, 0x20000, v2
  s_lshl_b32 s33, s29, 6
  s_mul_i32 s33, s33, 1280
  s_mul_i32 s34, s30, 160
  s_add_u32 s33, s33, s34
  v_and_b32 v81, 15, v80
  v_lshrrev_b32 v82, 4, v80
  s_lshl_b32 s33, s29, 6
  s_lshl_b32 s34, s42, 4
  s_add_u32 s33, s33, s34
  s_mul_i32 s33, s33, 1280
  s_mul_i32 s34, s30, 160
  s_add_u32 s33, s33, s34
  v_mul_u32_u24 v81, 1280, v81
  v_add_u32 v81, s33, v81
  v_lshl_add_u32 v7, v82, 3, v81
  s_and_b32 s34, s30, 1
  s_cmp_eq_u32 s34, 0
  s_cselect_b32 s33, 128, 0
  v_add_u32 v7, s33, v7
  s_cmp_eq_u32 s41, 0
  s_cselect_b32 s33, 0, 0x80000000
  v_or_b32 v7, s33, v7
  v_and_b32 v83, 1, v82
  v_lshl_add_u32 v81, v83, 5, v81
  v_lshrrev_b32 v83, 1, v82
  v_lshl_add_u32 v81, v83, 4, v81
  s_lshl_b32 s33, s41, 6
  s_lshl_b32 s34, s34, 5
  s_add_u32 s33, s33, s34
  v_add_u32 v6, s33, v81
  s_mul_i32 s33, s42, 5120
  v_add_u32 v8, s33, v1
  s_mul_i32 s43, s30, 240640
  s_mul_i32 s33, s28, 1024
  s_add_u32 s43, s43, s33
  s_add_u32 s43, s43, 25304064
  s_add_u32 s46, s33, 0
  s_lshl_b32 s33, s29, 2
  s_add_u32 s33, s33, s42
  s_mul_i32 s44, s33, 27648
  s_lshl_b32 s34, s41, 10
  s_add_u32 s44, s44, s34
  s_add_u32 s44, s44, 7340032
  s_mul_i32 s45, s33, 20480
  s_add_u32 s45, s45, s34
  s_add_u32 s45, s45, 11010048
  s_waitcnt vmcnt(40)
  s_barrier
  s_mov_b32 m0, 24576
  s_nop 0
  buffer_load_dwordx4 v62, s[4:7], s38 offen lds
  s_mov_b32 m0, 25600
  s_nop 0
  buffer_load_dwordx4 v64, s[4:7], s38 offen lds
  s_mov_b32 m0, 26624
  s_nop 0
  buffer_load_dwordx4 v62, s[4:7], s39 offen lds
  s_mov_b32 m0, 27648
  s_nop 0
  buffer_load_dwordx4 v64, s[4:7], s39 offen lds
  s_mov_b32 m0, 28672
  s_nop 0
  buffer_load_dwordx4 v62, s[4:7], s40 offen lds
  s_mov_b32 m0, 29696
  s_nop 0
  buffer_load_dwordx4 v64, s[4:7], s40 offen lds
  s_mov_b32 m0, 30720
  s_nop 0
  buffer_load_dwordx4 v62, s[4:7], s35 offen lds
  s_mov_b32 m0, 31744
  s_nop 0
  buffer_load_dwordx4 v64, s[4:7], s35 offen lds
  s_add_u32 s38, s38, 128
  s_add_u32 s39, s39, 128
  s_add_u32 s40, s40, 128
  s_add_u32 s35, s35, 128
  s_mov_b32 m0, 32768
  s_nop 0
  buffer_load_dwordx4 v62, s[4:7], s38 offen lds
  s_mov_b32 m0, 33792
  s_nop 0
  buffer_load_dwordx4 v64, s[4:7], s38 offen lds
  s_mov_b32 m0, 34816
  s_nop 0
  buffer_load_dwordx4 v62, s[4:7], s39 offen lds
  s_mov_b32 m0, 35840
  s_nop 0
  buffer_load_dwordx4 v64, s[4:7], s39 offen lds
  s_mov_b32 m0, 36864
  s_nop 0
  buffer_load_dwordx4 v62, s[4:7], s40 offen lds
  s_mov_b32 m0, 37888
  s_nop 0
  buffer_load_dwordx4 v64, s[4:7], s40 offen lds
  s_mov_b32 m0, 38912
  s_nop 0
  buffer_load_dwordx4 v62, s[4:7], s35 offen lds
  s_mov_b32 m0, 39936
  s_nop 0
  buffer_load_dwordx4 v64, s[4:7], s35 offen lds
  s_add_u32 s38, s38, 128
  s_add_u32 s39, s39, 128
  s_add_u32 s40, s40, 128
  s_add_u32 s35, s35, 128
  s_waitcnt vmcnt(40)
  s_barrier
  s_mov_b32 m0, 40960
  s_nop 0
  buffer_load_dwordx4 v62, s[4:7], s38 offen lds
  s_mov_b32 m0, 41984
  s_nop 0
  buffer_load_dwordx4 v64, s[4:7], s38 offen lds
  s_mov_b32 m0, 43008
  s_nop 0
  buffer_load_dwordx4 v62, s[4:7], s39 offen lds
  s_mov_b32 m0, 44032
  s_nop 0
  buffer_load_dwordx4 v64, s[4:7], s39 offen lds
  s_mov_b32 m0, 45056
  s_nop 0
  buffer_load_dwordx4 v62, s[4:7], s40 offen lds
  s_mov_b32 m0, 46080
  s_nop 0
  buffer_load_dwordx4 v64, s[4:7], s40 offen lds
  s_mov_b32 m0, 47104
  s_nop 0
  buffer_load_dwordx4 v62, s[4:7], s35 offen lds
  s_mov_b32 m0, 48128
  s_nop 0
  buffer_load_dwordx4 v64, s[4:7], s35 offen lds
  s_add_u32 s38, s38, 128
  s_add_u32 s39, s39, 128
  s_add_u32 s40, s40, 128
  s_add_u32 s35, s35, 128
  s_mov_b32 m0, 49152
  s_nop 0
  buffer_load_dwordx4 v62, s[4:7], s38 offen lds
  s_mov_b32 m0, 50176
  s_nop 0
  buffer_load_dwordx4 v64, s[4:7], s38 offen lds
  s_mov_b32 m0, 51200
  s_nop 0
  buffer_load_dwordx4 v62, s[4:7], s39 offen lds
  s_mov_b32 m0, 52224
  s_nop 0
  buffer_load_dwordx4 v64, s[4:7], s39 offen lds
  s_mov_b32 m0, 53248
  s_nop 0
  buffer_load_dwordx4 v62, s[4:7], s40 offen lds
  s_mov_b32 m0, 54272
  s_nop 0
  buffer_load_dwordx4 v64, s[4:7], s40 offen lds
  s_mov_b32 m0, 55296
  s_nop 0
  buffer_load_dwordx4 v62, s[4:7], s35 offen lds
  s_mov_b32 m0, 56320
  s_nop 0
  buffer_load_dwordx4 v64, s[4:7], s35 offen lds
  s_add_u32 s38, s38, 128
  s_add_u32 s39, s39, 128
  s_add_u32 s40, s40, 128
  s_add_u32 s35, s35, 128
  s_waitcnt vmcnt(40)
  s_barrier
  s_mov_b32 m0, 57344
  s_nop 0
  buffer_load_dwordx4 v62, s[4:7], s38 offen lds
  s_mov_b32 m0, 58368
  s_nop 0
  buffer_load_dwordx4 v64, s[4:7], s38 offen lds
  s_mov_b32 m0, 59392
  s_nop 0
  buffer_load_dwordx4 v62, s[4:7], s39 offen lds
  s_mov_b32 m0, 60416
  s_nop 0
  buffer_load_dwordx4 v64, s[4:7], s39 offen lds
  s_mov_b32 m0, 61440
  s_nop 0
  buffer_load_dwordx4 v62, s[4:7], s40 offen lds
  s_mov_b32 m0, 62464
  s_nop 0
  buffer_load_dwordx4 v64, s[4:7], s40 offen lds
  s_mov_b32 m0, 63488
  s_nop 0
  buffer_load_dwordx4 v62, s[4:7], s35 offen lds
  s_mov_b32 m0, 64512
  s_nop 0
  buffer_load_dwordx4 v64, s[4:7], s35 offen lds
  s_add_u32 s38, s38, 128
  s_add_u32 s39, s39, 128
  s_add_u32 s40, s40, 128
  s_add_u32 s35, s35, 128
  s_mov_b32 m0, 65536
  s_nop 0
  buffer_load_dwordx4 v62, s[4:7], s38 offen lds
  s_mov_b32 m0, 66560
  s_nop 0
  buffer_load_dwordx4 v64, s[4:7], s38 offen lds
  s_mov_b32 m0, 67584
  s_nop 0
  buffer_load_dwordx4 v62, s[4:7], s39 offen lds
  s_mov_b32 m0, 68608
  s_nop 0
  buffer_load_dwordx4 v64, s[4:7], s39 offen lds
  s_mov_b32 m0, 69632
  s_nop 0
  buffer_load_dwordx4 v62, s[4:7], s40 offen lds
  s_mov_b32 m0, 70656
  s_nop 0
  buffer_load_dwordx4 v64, s[4:7], s40 offen lds
  s_mov_b32 m0, 71680
  s_nop 0
  buffer_load_dwordx4 v62, s[4:7], s35 offen lds
  s_mov_b32 m0, 72704
  s_nop 0
  buffer_load_dwordx4 v64, s[4:7], s35 offen lds
  s_add_u32 s38, s38, 128
  s_add_u32 s39, s39, 128
  s_add_u32 s40, s40, 128
  s_add_u32 s35, s35, 128
  s_waitcnt vmcnt(40)
  s_barrier
  s_mov_b32 m0, 73728
  s_nop 0
  buffer_load_dwordx4 v62, s[4:7], s38 offen lds
  s_mov_b32 m0, 74752
  s_nop 0
  buffer_load_dwordx4 v64, s[4:7], s38 offen lds
  s_mov_b32 m0, 75776
  s_nop 0
  buffer_load_dwordx4 v62, s[4:7], s39 offen lds
  s_mov_b32 m0, 76800
  s_nop 0
  buffer_load_dwordx4 v64, s[4:7], s39 offen lds
  s_mov_b32 m0, 77824
  s_nop 0
  buffer_load_dwordx4 v62, s[4:7], s40 offen lds
  s_mov_b32 m0, 78848
  s_nop 0
  buffer_load_dwordx4 v64, s[4:7], s40 offen lds
  s_mov_b32 m0, 79872
  s_nop 0
  buffer_load_dwordx4 v62, s[4:7], s35 offen lds
  s_mov_b32 m0, 80896
  s_nop 0
  buffer_load_dwordx4 v64, s[4:7], s35 offen lds
  s_add_u32 s38, s38, 128
  s_add_u32 s39, s39, 128
  s_add_u32 s40, s40, 128
  s_add_u32 s35, s35, 128
  s_mov_b32 m0, 0
  s_nop 0
  buffer_load_dwordx4 v62, s[4:7], s38 offen lds
  s_mov_b32 m0, 1024
  s_nop 0
  buffer_load_dwordx4 v64, s[4:7], s38 offen lds
  s_mov_b32 m0, 2048
  s_nop 0
  buffer_load_dwordx4 v62, s[4:7], s39 offen lds
  s_mov_b32 m0, 3072
  s_nop 0
  buffer_load_dwordx4 v64, s[4:7], s39 offen lds
  s_mov_b32 m0, 4096
  s_nop 0
  buffer_load_dwordx4 v62, s[4:7], s40 offen lds
  s_mov_b32 m0, 5120
  s_nop 0
  buffer_load_dwordx4 v64, s[4:7], s40 offen lds
  s_mov_b32 m0, 6144
  s_nop 0
  buffer_load_dwordx4 v62, s[4:7], s35 offen lds
  s_mov_b32 m0, 7168
  s_nop 0
  buffer_load_dwordx4 v64, s[4:7], s35 offen lds
  s_add_u32 s38, s38, 128
  s_add_u32 s39, s39, 128
  s_add_u32 s40, s40, 128
  s_add_u32 s35, s35, 128
  s_waitcnt vmcnt(40)
  s_barrier
  s_mov_b32 m0, 8192
  s_nop 0
  buffer_load_dwordx4 v62, s[4:7], s38 offen lds
  s_mov_b32 m0, 9216
  s_nop 0
  buffer_load_dwordx4 v64, s[4:7], s38 offen lds
  s_mov_b32 m0, 10240
  s_nop 0
  buffer_load_dwordx4 v62, s[4:7], s39 offen lds
  s_mov_b32 m0, 11264
  s_nop 0
  buffer_load_dwordx4 v64, s[4:7], s39 offen lds
  s_mov_b32 m0, 12288
  s_nop 0
  buffer_load_dwordx4 v62, s[4:7], s40 offen lds
  s_mov_b32 m0, 13312
  s_nop 0
  buffer_load_dwordx4 v64, s[4:7], s40 offen lds
  s_mov_b32 m0, 14336
  s_nop 0
  buffer_load_dwordx4 v62, s[4:7], s35 offen lds
  s_mov_b32 m0, 15360
  s_nop 0
  buffer_load_dwordx4 v64, s[4:7], s35 offen lds
  s_add_u32 s38, s38, 128
  s_add_u32 s39, s39, 128
  s_add_u32 s40, s40, 128
  s_add_u32 s35, s35, 128
  s_mov_b32 m0, 16384
  s_nop 0
  buffer_load_dwordx4 v62, s[4:7], s38 offen lds
  s_mov_b32 m0, 17408
  s_nop 0
  buffer_load_dwordx4 v64, s[4:7], s38 offen lds
  s_mov_b32 m0, 18432
  s_nop 0
  buffer_load_dwordx4 v62, s[4:7], s39 offen lds
  s_mov_b32 m0, 19456
  s_nop 0
  buffer_load_dwordx4 v64, s[4:7], s39 offen lds
  s_mov_b32 m0, 20480
  s_nop 0
  buffer_load_dwordx4 v62, s[4:7], s40 offen lds
  s_mov_b32 m0, 21504
  s_nop 0
  buffer_load_dwordx4 v64, s[4:7], s40 offen lds
  s_mov_b32 m0, 22528
  s_nop 0
  buffer_load_dwordx4 v62, s[4:7], s35 offen lds
  s_mov_b32 m0, 23552
  s_nop 0
  buffer_load_dwordx4 v64, s[4:7], s35 offen lds
  s_add_u32 s38, s38, 128
  s_add_u32 s39, s39, 128
  s_add_u32 s40, s40, 128
  s_add_u32 s35, s35, 128
  s_waitcnt vmcnt(40)
  s_barrier
  s_mov_b32 m0, 24576
  s_nop 0
  buffer_load_dwordx4 v62, s[4:7], s38 offen lds
  s_mov_b32 m0, 25600
  s_nop 0
  buffer_load_dwordx4 v64, s[4:7], s38 offen lds
  s_mov_b32 m0, 26624
  s_nop 0
  buffer_load_dwordx4 v62, s[4:7], s39 offen lds
  s_mov_b32 m0, 27648
  s_nop 0
  buffer_load_dwordx4 v64, s[4:7], s39 offen lds
  s_mov_b32 m0, 28672
  s_nop 0
  buffer_load_dwordx4 v62, s[4:7], s40 offen lds
  s_mov_b32 m0, 29696
  s_nop 0
  buffer_load_dwordx4 v64, s[4:7], s40 offen lds
  s_mov_b32 m0, 30720
  s_nop 0
  buffer_load_dwordx4 v62, s[4:7], s35 offen lds
  s_mov_b32 m0, 31744
  s_nop 0
  buffer_load_dwordx4 v64, s[4:7], s35 offen lds
  s_add_u32 s38, s38, 128
  s_add_u32 s39, s39, 128
  s_add_u32 s40, s40, 128
  s_add_u32 s35, s35, 128
  s_mov_b32 m0, 32768
  s_nop 0
  buffer_load_dwordx4 v62, s[4:7], s38 offen lds
  s_mov_b32 m0, 33792
  s_nop 0
  buffer_load_dwordx4 v64, s[4:7], s38 offen lds
  s_mov_b32 m0, 34816
  s_nop 0
  buffer_load_dwordx4 v62, s[4:7], s39 offen lds
  s_mov_b32 m0, 35840
  s_nop 0
  buffer_load_dwordx4 v64, s[4:7], s39 offen lds
  s_mov_b32 m0, 36864
  s_nop 0
  buffer_load_dwordx4 v62, s[4:7], s40 offen lds
  s_mov_b32 m0, 37888
  s_nop 0
  buffer_load_dwordx4 v64, s[4:7], s40 offen lds
  s_mov_b32 m0, 38912
  s_nop 0
  buffer_load_dwordx4 v62, s[4:7], s35 offen lds
  s_mov_b32 m0, 39936
  s_nop 0
  buffer_load_dwordx4 v64, s[4:7], s35 offen lds
  s_add_u32 s38, s38, 128
  s_add_u32 s39, s39, 128
  s_add_u32 s40, s40, 128
  s_add_u32 s35, s35, 128
  s_waitcnt vmcnt(40)
  s_barrier
  s_mov_b32 m0, 40960
  s_nop 0
  buffer_load_dwordx4 v62, s[4:7], s38 offen lds
  s_mov_b32 m0, 41984
  s_nop 0
  buffer_load_dwordx4 v64, s[4:7], s38 offen lds
  s_mov_b32 m0, 43008
  s_nop 0
  buffer_load_dwordx4 v62, s[4:7], s39 offen lds
  s_mov_b32 m0, 44032
  s_nop 0
  buffer_load_dwordx4 v64, s[4:7], s39 offen lds
  s_mov_b32 m0, 45056
  s_nop 0
  buffer_load_dwordx4 v62, s[4:7], s40 offen lds
  s_mov_b32 m0, 46080
  s_nop 0
  buffer_load_dwordx4 v64, s[4:7], s40 offen lds
  s_mov_b32 m0, 47104
  s_nop 0
  buffer_load_dwordx4 v62, s[4:7], s35 offen lds
  s_mov_b32 m0, 48128
  s_nop 0
  buffer_load_dwordx4 v64, s[4:7], s35 offen lds
  s_add_u32 s38, s38, 128
  s_add_u32 s39, s39, 128
  s_add_u32 s40, s40, 128
  s_add_u32 s35, s35, 128
  s_mov_b32 m0, 49152
  s_nop 0
  buffer_load_dwordx4 v62, s[4:7], s38 offen lds
  s_mov_b32 m0, 50176
  s_nop 0
  buffer_load_dwordx4 v64, s[4:7], s38 offen lds
  s_mov_b32 m0, 51200
  s_nop 0
  buffer_load_dwordx4 v62, s[4:7], s39 offen lds
  s_mov_b32 m0, 52224
  s_nop 0
  buffer_load_dwordx4 v64, s[4:7], s39 offen lds
  s_mov_b32 m0, 53248
  s_nop 0
  buffer_load_dwordx4 v62, s[4:7], s40 offen lds
  s_mov_b32 m0, 54272
  s_nop 0
  buffer_load_dwordx4 v64, s[4:7], s40 offen lds
  s_mov_b32 m0, 55296
  s_nop 0
  buffer_load_dwordx4 v62, s[4:7], s35 offen lds
  s_mov_b32 m0, 56320
  s_nop 0
  buffer_load_dwordx4 v64, s[4:7], s35 offen lds
  s_add_u32 s38, s38, 128
  s_add_u32 s39, s39, 128
  s_add_u32 s40, s40, 128
  s_add_u32 s35, s35, 128
  s_waitcnt vmcnt(40)
  s_barrier
  s_mov_b32 m0, 57344
  s_nop 0
  buffer_load_dwordx4 v62, s[4:7], s38 offen lds
  s_mov_b32 m0, 58368
  s_nop 0
  buffer_load_dwordx4 v64, s[4:7], s38 offen lds
  s_mov_b32 m0, 59392
  s_nop 0
  buffer_load_dwordx4 v62, s[4:7], s39 offen lds
  s_mov_b32 m0, 60416
  s_nop 0
  buffer_load_dwordx4 v64, s[4:7], s39 offen lds
  s_mov_b32 m0, 61440
  s_nop 0
  buffer_load_dwordx4 v62, s[4:7], s40 offen lds
  s_mov_b32 m0, 62464
  s_nop 0
  buffer_load_dwordx4 v64, s[4:7], s40 offen lds
  s_mov_b32 m0, 63488
  s_nop 0
  buffer_load_dwordx4 v62, s[4:7], s35 offen lds
  s_mov_b32 m0, 64512
  s_nop 0
  buffer_load_dwordx4 v64, s[4:7], s35 offen lds
  s_add_u32 s38, s38, 128
  s_add_u32 s39, s39, 128
  s_add_u32 s40, s40, 128
  s_add_u32 s35, s35, 128
  s_mov_b32 m0, 65536
  s_nop 0
  buffer_load_dwordx4 v62, s[4:7], s38 offen lds
  s_mov_b32 m0, 66560
  s_nop 0
  buffer_load_dwordx4 v64, s[4:7], s38 offen lds
  s_mov_b32 m0, 67584
  s_nop 0
  buffer_load_dwordx4 v62, s[4:7], s39 offen lds
  s_mov_b32 m0, 68608
  s_nop 0
  buffer_load_dwordx4 v64, s[4:7], s39 offen lds
  s_mov_b32 m0, 69632
  s_nop 0
  buffer_load_dwordx4 v62, s[4:7], s40 offen lds
  s_mov_b32 m0, 70656
  s_nop 0
  buffer_load_dwordx4 v64, s[4:7], s40 offen lds
  s_mov_b32 m0, 71680
  s_nop 0
  buffer_load_dwordx4 v62, s[4:7], s35 offen lds
  s_mov_b32 m0, 72704
  s_nop 0
  buffer_load_dwordx4 v64, s[4:7], s35 offen lds
  s_add_u32 s38, s38, 128
  s_add_u32 s39, s39, 128
  s_add_u32 s40, s40, 128
  s_add_u32 s35, s35, 128
  s_waitcnt vmcnt(40)
  s_barrier
  s_mov_b32 m0, 73728
  s_nop 0
  buffer_load_dwordx4 v62, s[4:7], s38 offen lds
  s_mov_b32 m0, 74752
  s_nop 0
  buffer_load_dwordx4 v64, s[4:7], s38 offen lds
  s_mov_b32 m0, 75776
  s_nop 0
  buffer_load_dwordx4 v62, s[4:7], s39 offen lds
  s_mov_b32 m0, 76800
  s_nop 0
  buffer_load_dwordx4 v64, s[4:7], s39 offen lds
  s_mov_b32 m0, 77824
  s_nop 0
  buffer_load_dwordx4 v62, s[4:7], s40 offen lds
  s_mov_b32 m0, 78848
  s_nop 0
  buffer_load_dwordx4 v64, s[4:7], s40 offen lds
  s_mov_b32 m0, 79872
  s_nop 0
  buffer_load_dwordx4 v62, s[4:7], s35 offen lds
  s_mov_b32 m0, 80896
  s_nop 0
  buffer_load_dwordx4 v64, s[4:7], s35 offen lds
  s_add_u32 s38, s38, 128
  s_add_u32 s39, s39, 128
  s_add_u32 s40, s40, 128
  s_add_u32 s35, s35, 128
  s_mov_b32 m0, 0
  s_nop 0
  buffer_load_dwordx4 v62, s[4:7], s38 offen lds
  s_mov_b32 m0, 1024
  s_nop 0
  buffer_load_dwordx4 v64, s[4:7], s38 offen lds
  s_mov_b32 m0, 2048
  s_nop 0
  buffer_load_dwordx4 v62, s[4:7], s39 offen lds
  s_mov_b32 m0, 3072
  s_nop 0
  buffer_load_dwordx4 v64, s[4:7], s39 offen lds
  s_mov_b32 m0, 4096
  s_nop 0
  buffer_load_dwordx4 v62, s[4:7], s40 offen lds
  s_mov_b32 m0, 5120
  s_nop 0
  buffer_load_dwordx4 v64, s[4:7], s40 offen lds
  s_mov_b32 m0, 6144
  s_nop 0
  buffer_load_dwordx4 v62, s[4:7], s35 offen lds
  s_mov_b32 m0, 7168
  s_nop 0
  buffer_load_dwordx4 v64, s[4:7], s35 offen lds
  s_add_u32 s38, s38, 128
  s_add_u32 s39, s39, 128
  s_add_u32 s40, s40, 128
  s_add_u32 s35, s35, 128
  s_waitcnt vmcnt(40)
  s_barrier
  s_mov_b32 m0, 8192
  s_nop 0
  buffer_load_dwordx4 v62, s[4:7], s38 offen lds
  s_mov_b32 m0, 9216
  s_nop 0
  buffer_load_dwordx4 v64, s[4:7], s38 offen lds
  s_mov_b32 m0, 10240
  s_nop 0
  buffer_load_dwordx4 v62, s[4:7], s39 offen lds
  s_mov_b32 m0, 11264
  s_nop 0
  buffer_load_dwordx4 v64, s[4:7], s39 offen lds
  s_mov_b32 m0, 12288
  s_nop 0
  buffer_load_dwordx4 v62, s[4:7], s40 offen lds
  s_mov_b32 m0, 13312
  s_nop 0
  buffer_load_dwordx4 v64, s[4:7], s40 offen lds
  s_mov_b32 m0, 14336
  s_nop 0
  buffer_load_dwordx4 v62, s[4:7], s35 offen lds
  s_mov_b32 m0, 15360
  s_nop 0
  buffer_load_dwordx4 v64, s[4:7], s35 offen lds
  s_add_u32 s38, s38, 128
  s_add_u32 s39, s39, 128
  s_add_u32 s40, s40, 128
  s_add_u32 s35, s35, 128
  s_add_u32 m0, s46, 81920
  s_nop 0
  buffer_load_dwordx4 v1, s[8:11], s43 offen lds
  s_add_u32 s43, s43, 8192
  s_add_u32 m0, s46, 90112
  s_nop 0
  buffer_load_dwordx4 v1, s[8:11], s43 offen lds
  s_add_u32 s43, s43, 8192
  buffer_load_dwordx4 v[20:23], v1, s[8:11], s45 offen
  s_add_u32 s45, s45, 2048
  s_waitcnt vmcnt(35)
  s_barrier
  s_add_u32 m0, s46, 98304
  s_nop 0
  buffer_load_dwordx4 v1, s[8:11], s43 offen lds
  s_add_u32 s43, s43, 8192
  buffer_load_dwordx4 v[24:27], v1, s[8:11], s45 offen
  s_add_u32 s45, s45, 2048
  s_add_u32 m0, s46, 106496
  s_nop 0
  buffer_load_dwordx4 v1, s[8:11], s43 offen lds
  s_add_u32 s43, s43, 8192
  buffer_load_dwordx4 v[28:31], v1, s[8:11], s45 offen
  s_add_u32 s45, s45, 2048
  s_add_u32 m0, s46, 114688
  s_nop 0
  buffer_load_dwordx4 v1, s[8:11], s43 offen lds
  s_add_u32 s43, s43, 8192
  buffer_load_dwordx4 v[32:35], v1, s[8:11], s45 offen
  s_add_u32 s45, s45, 2048
  s_waitcnt vmcnt(25)
  s_barrier
  s_add_u32 m0, s46, 122880
  s_nop 0
  buffer_load_dwordx4 v1, s[8:11], s43 offen lds
  s_add_u32 s43, s43, 8192
  s_add_u32 m0, s46, 131072
  s_nop 0
  buffer_load_dwordx4 v1, s[8:11], s43 offen lds
  s_add_u32 s43, s43, 8192
  buffer_load_dwordx4 v[36:39], v1, s[8:11], s45 offen
  s_add_u32 s45, s45, 2048
  s_add_u32 m0, s46, 139264
  s_nop 0
  buffer_load_dwordx4 v1, s[8:11], s43 offen lds
  s_add_u32 s43, s43, 8192
  buffer_load_dwordx4 v[40:43], v1, s[8:11], s45 offen
  s_add_u32 s45, s45, 2048
  s_waitcnt vmcnt(14)
  s_barrier
  s_add_u32 m0, s46, 147456
  s_nop 0
  buffer_load_dwordx4 v1, s[8:11], s43 offen lds
  s_add_u32 s43, s43, 8192
  buffer_load_dwordx4 v[44:47], v1, s[8:11], s45 offen
  s_add_u32 s45, s45, 2048
  s_add_u32 m0, s46, 155648
  s_nop 0
  buffer_load_dwordx4 v1, s[8:11], s43 offen lds
  s_add_u32 s43, s43, 8192
  buffer_load_dwordx4 v[48:51], v1, s[8:11], s45 offen
  s_add_u32 s45, s45, 2048
K2_p3:
  s_setprio 0
  s_waitcnt vmcnt(16)
  s_barrier
  ds_read_b128 v[156:159], v3 offset:16384
  ds_read_b128 v[160:163], v3 offset:17408
  ds_read_b128 v[164:167], v3 offset:18432
  ds_read_b128 v[168:171], v3 offset:19456
  ds_read_b128 v[172:175], v3 offset:20480
  v_mov_b32 v96, 0
  s_add_u32 m0, s46, 0
  s_nop 0
  buffer_load_dwordx4 v1, s[8:11], s43 offen lds
  s_add_u32 s43, s43, 8192
  s_add_u32 m0, s46, 8192
  s_nop 0
  buffer_load_dwordx4 v1, s[8:11], s43 offen lds
  s_add_u32 s43, s43, 8192
  s_add_u32 m0, s46, 16384
  s_cmp_ge_u32 s28, 4
  s_cselect_b32 s33, 0xfffc5400, 0
  s_add_u32 s43, s43, s33
  buffer_load_dwordx4 v1, s[8:11], s43 offen lds
  s_add_u32 s43, s43, 8192
  s_cmp_ge_u32 s28, 4
  s_cselect_b32 s33, 0, 0xfffc5400
  s_add_u32 s43, s43, s33
  s_add_u32 m0, s46, 24576
  s_nop 0
  buffer_load_dwordx4 v1, s[8:11], s43 offen lds
  s_add_u32 s43, s43, 8192
  s_waitcnt vmcnt(4)
  s_barrier
  s_cmp_lg_u32 s28, 0
  s_cbranch_scc1 K2_noflag
  s_lshl_b32 s33, s30, 3
  s_add_u32 s33, s33, s54
  v_mov_b32 v54, 0
  s_mov_b64 exec, 1
  buffer_store_dwordx2 v[52:53], v54, s[8:11], s33 offen sc1
  s_mov_b64 exec, -1
K2_noflag:
  ds_read_b128 v[176:179], v3 offset:26624
  ds_read_b128 v[180:183], v3 offset:27648
  ds_read_b128 v[184:187], v3 offset:28672
  ds_read_b128 v[188:191], v3 offset:29696
  ds_read_b128 v[192:195], v3 offset:30720
  s_waitcnt vmcnt(19) lgkmcnt(5)
  s_add_u32 m0, s46, 32768
  s_nop 0
  buffer_load_dwordx4 v1, s[8:11], s43 offen lds
  s_add_u32 s43, s43, 8192
  v_mfma_f32_16x16x32_bf16 v[136:139], v[156:159], v[20:23], 0
  s_add_u32 m0, s46, 40960
  s_nop 0
  buffer_load_dwordx4 v1, s[8:11], s43 offen lds
  s_add_u32 s43, s43, 8192
  v_mfma_f32_16x16x32_bf16 v[140:143], v[160:163], v[20:23], 0
  s_add_u32 m0, s46, 49152
  s_nop 0
  buffer_load_dwordx4 v1, s[8:11], s43 offen lds
  s_add_u32 s43, s43, 8192
  v_mfma_f32_16x16x32_bf16 v[144:147], v[164:167], v[20:23], 0
  s_add_u32 m0, s46, 57344
  s_nop 0
  buffer_load_dwordx4 v1, s[8:11], s43 offen lds
  s_add_u32 s43, s43, 8192
  v_mfma_f32_16x16x32_bf16 v[148:151], v[168:171], v[20:23], 0
  v_mfma_f32_16x16x32_bf16 v[152:155], v[172:175], v[20:23], 0
  s_waitcnt vmcnt(20)
  s_barrier
  ds_read_b128 v[156:159], v3 offset:36864
  ds_read_b128 v[160:163], v3 offset:37888
  ds_read_b128 v[164:167], v3 offset:38912
  ds_read_b128 v[168:171], v3 offset:39936
  ds_read_b128 v[172:175], v3 offset:40960
  s_waitcnt vmcnt(21) lgkmcnt(5)
  s_add_u32 m0, s46, 65536
  s_nop 0
  buffer_load_dwordx4 v1, s[8:11], s43 offen lds
  s_add_u32 s43, s43, 8192
  v_mfma_f32_16x16x32_bf16 v[136:139], v[176:179], v[24:27], v[136:139]
  buffer_load_dwordx4 v[20:23], v1, s[8:11], s45 offen
  s_add_u32 s45, s45, 2048
  v_mfma_f32_16x16x32_bf16 v[140:143], v[180:183], v[24:27], v[140:143]
  s_add_u32 m0, s46, 73728
  s_nop 0
  buffer_load_dwordx4 v1, s[8:11], s43 offen lds
  s_add_u32 s43, s43, 8192
  v_mfma_f32_16x16x32_bf16 v[144:147], v[184:187], v[24:27], v[144:147]
  v_mfma_f32_16x16x32_bf16 v[148:151], v[188:191], v[24:27], v[148:151]
  v_mfma_f32_16x16x32_bf16 v[152:155], v[192:195], v[24:27], v[152:155]
  s_waitcnt vmcnt(21)
  s_barrier
  ds_read_b128 v[176:179], v3 offset:47104
  ds_read_b128 v[180:183], v3 offset:48128
  ds_read_b128 v[184:187], v3 offset:49152
  ds_read_b128 v[188:191], v3 offset:50176
  ds_read_b128 v[192:195], v3 offset:51200
  s_waitcnt vmcnt(22) lgkmcnt(5)
  s_add_u32 m0, s46, 81920
  s_nop 0
  buffer_load_dwordx4 v1, s[8:11], s43 offen lds
  s_add_u32 s43, s43, 8192
  v_mfma_f32_16x16x32_bf16 v[136:139], v[156:159], v[28:31], v[136:139]
  buffer_load_dwordx4 v[24:27], v1, s[8:11], s45 offen
  s_add_u32 s45, s45, 2048
  v_mfma_f32_16x16x32_bf16 v[140:143], v[160:163], v[28:31], v[140:143]
  s_add_u32 m0, s46, 90112
  s_nop 0
  buffer_load_dwordx4 v1, s[8:11], s43 offen lds
  s_add_u32 s43, s43, 8192
  v_mfma_f32_16x16x32_bf16 v[144:147], v[164:167], v[28:31], v[144:147]
  v_mfma_f32_16x16x32_bf16 v[148:151], v[168:171], v[28:31], v[148:151]
  v_mfma_f32_16x16x32_bf16 v[152:155], v[172:175], v[28:31], v[152:155]
  s_waitcnt vmcnt(21)
  s_barrier
  ds_read_b128 v[156:159], v3 offset:57344
  ds_read_b128 v[160:163], v3 offset:58368
  ds_read_b128 v[164:167], v3 offset:59392
  ds_read_b128 v[168:171], v3 offset:60416
  ds_read_b128 v[172:175], v3 offset:61440
  s_waitcnt vmcnt(23) lgkmcnt(5)
  s_add_u32 m0, s46, 98304
  s_nop 0
  buffer_load_dwordx4 v1, s[8:11], s43 offen lds
  s_add_u32 s43, s43, 8192
  v_mfma_f32_16x16x32_bf16 v[136:139], v[176:179], v[32:35], v[136:139]
  v_mfma_f32_16x16x32_bf16 v[140:143], v[180:183], v[32:35], v[140:143]
  v_mfma_f32_16x16x32_bf16 v[144:147], v[184:187], v[32:35], v[144:147]
  v_mfma_f32_16x16x32_bf16 v[148:151], v[188:191], v[32:35], v[148:151]
  v_mfma_f32_16x16x32_bf16 v[152:155], v[192:195], v[32:35], v[152:155]
  s_waitcnt vmcnt(20)
  s_barrier
  ds_read_b128 v[176:179], v4 offset:2048
  ds_read_b128 v[180:183], v4 offset:3072
  ds_read_b128 v[184:187], v4 offset:4096
  ds_read_b128 v[188:191], v4 offset:5120
  ds_read_b128 v[192:195], v4 offset:6144
  s_waitcnt vmcnt(21) lgkmcnt(5)
  s_add_u32 m0, s46, 106496
  s_nop 0
  buffer_load_dwordx4 v1, s[8:11], s43 offen lds
  s_add_u32 s43, s43, 8192
  v_mfma_f32_16x16x32_bf16 v[136:139], v[156:159], v[36:39], v[136:139]
  s_add_u32 m0, s46, 114688
  s_nop 0
  buffer_load_dwordx4 v1, s[8:11], s43 offen lds
  s_add_u32 s43, s43, 8192
  v_mfma_f32_16x16x32_bf16 v[140:143], v[160:163], v[36:39], v[140:143]
  v_mfma_f32_16x16x32_bf16 v[144:147], v[164:167], v[36:39], v[144:147]
  v_mfma_f32_16x16x32_bf16 v[148:151], v[168:171], v[36:39], v[148:151]
  v_mfma_f32_16x16x32_bf16 v[152:155], v[172:175], v[36:39], v[152:155]
  s_waitcnt vmcnt(20)
  s_barrier
  ds_read_b128 v[156:159], v4 offset:12288
  ds_read_b128 v[160:163], v4 offset:13312
  ds_read_b128 v[164:167], v4 offset:14336
  ds_read_b128 v[168:171], v4 offset:15360
  ds_read_b128 v[172:175], v4 offset:16384
  s_waitcnt vmcnt(21) lgkmcnt(5)
  s_add_u32 m0, s46, 122880
  s_nop 0
  buffer_load_dwordx4 v1, s[8:11], s43 offen lds
  s_add_u32 s43, s43, 8192
  v_mfma_f32_16x16x32_bf16 v[136:139], v[176:179], v[40:43], v[136:139]
  v_mfma_f32_16x16x32_bf16 v[140:143], v[180:183], v[40:43], v[140:143]
  v_mfma_f32_16x16x32_bf16 v[144:147], v[184:187], v[40:43], v[144:147]
  v_mfma_f32_16x16x32_bf16 v[148:151], v[188:191], v[40:43], v[148:151]
  v_mfma_f32_16x16x32_bf16 v[152:155], v[192:195], v[40:43], v[152:155]
  s_waitcnt vmcnt(19)
  s_barrier
  ds_read_b128 v[176:179], v4 offset:22528
  ds_read_b128 v[180:183], v4 offset:23552
  ds_read_b128 v[184:187], v4 offset:24576
  ds_read_b128 v[188:191], v4 offset:25600
  ds_read_b128 v[192:195], v4 offset:26624
  s_waitcnt vmcnt(20) lgkmcnt(5)
  s_add_u32 m0, s46, 131072
  s_nop 0
  buffer_load_dwordx4 v1, s[8:11], s43 offen lds
  s_add_u32 s43, s43, 8192
  v_mfma_f32_16x16x32_bf16 v[136:139], v[156:159], v[44:47], v[136:139]
  s_cmp_eq_u32 s28, 0
  s_cselect_b32 s33, s54, 0x80000000
  buffer_load_dwordx2 v[54:55], v56, s[8:11], s33 offen sc1
  v_mfma_f32_16x16x32_bf16 v[140:143], v[160:163], v[44:47], v[140:143]
  v_mfma_f32_16x16x32_bf16 v[144:147], v[164:167], v[44:47], v[144:147]
  v_mfma_f32_16x16x32_bf16 v[148:151], v[168:171], v[44:47], v[148:151]
  v_mfma_f32_16x16x32_bf16 v[152:155], v[172:175], v[44:47], v[152:155]
  s_waitcnt vmcnt(18)
  s_barrier
  ds_read_b128 v[156:159], v2 offset:0
  ds_read_b128 v[160:163], v2 offset:1024
  ds_read_b128 v[164:167], v2 offset:2048
  ds_read_b128 v[168:171], v2 offset:3072
  ds_read_b128 v[172:175], v2 offset:4096
  s_waitcnt vmcnt(20) lgkmcnt(5)
  s_add_u32 m0, s46, 139264
  s_nop 0
  buffer_load_dwordx4 v1, s[8:11], s43 offen lds
  s_add_u32 s43, s43, 8192
  v_mfma_f32_16x16x32_bf16 v[136:139], v[176:179], v[48:51], v[136:139]
  v_mfma_f32_16x16x32_bf16 v[140:143], v[180:183], v[48:51], v[140:143]
  v_mfma_f32_16x16x32_bf16 v[144:147], v[184:187], v[48:51], v[144:147]
  v_mfma_f32_16x16x32_bf16 v[148:151], v[188:191], v[48:51], v[148:151]
  v_mfma_f32_16x16x32_bf16 v[152:155], v[192:195], v[48:51], v[152:155]
  s_waitcnt vmcnt(18)
  s_barrier
  ds_read_b128 v[176:179], v2 offset:10240
  ds_read_b128 v[180:183], v2 offset:11264
  ds_read_b128 v[184:187], v2 offset:12288
  ds_read_b128 v[188:191], v2 offset:13312
  ds_read_b128 v[192:195], v2 offset:14336
  s_waitcnt vmcnt(11) lgkmcnt(5)
  s_add_u32 m0, s46, 147456
  s_nop 0
  buffer_load_dwordx4 v1, s[8:11], s43 offen lds
  s_add_u32 s43, s43, 8192
  v_mfma_f32_16x16x32_bf16 v[136:139], v[156:159], v[20:23], v[136:139]
  s_add_u32 m0, s46, 155648
  s_nop 0
  buffer_load_dwordx4 v1, s[8:11], s43 offen lds
  s_add_u32 s43, s43, 8192
  v_mfma_f32_16x16x32_bf16 v[140:143], v[160:163], v[20:23], v[140:143]
  v_mfma_f32_16x16x32_bf16 v[144:147], v[164:167], v[20:23], v[144:147]
  v_mfma_f32_16x16x32_bf16 v[148:151], v[168:171], v[20:23], v[148:151]
  v_mfma_f32_16x16x32_bf16 v[152:155], v[172:175], v[20:23], v[152:155]
  s_waitcnt vmcnt(15) lgkmcnt(0)
  s_cmp_lg_u32 s28, 0
  s_cbranch_scc1 K2_fok
  s_waitcnt vmcnt(3)
  v_cmp_ne_u32 vcc, s52, v54
  s_nop 3
  s_mov_b64 s[48:49], vcc
  v_cmp_ne_u32 vcc, s53, v55
  s_nop 3
  s_or_b64 s[48:49], s[48:49], vcc
  s_cmp_lg_u64 s[48:49], 0
  s_cbranch_scc1 K2_fspin
K2_fok:
  s_barrier
  buffer_load_dwordx4 v[196:199], v1, s[8:11], s44 offen
  s_add_u32 s44, s44, 2048
  buffer_load_dwordx4 v[200:203], v1, s[8:11], s44 offen
  s_add_u32 s44, s44, 2048
  ds_read_b128 v[156:159], v2 offset:20480
  ds_read_b128 v[160:163], v2 offset:21504
  ds_read_b128 v[164:167], v2 offset:22528
  ds_read_b128 v[168:171], v2 offset:23552
  ds_read_b128 v[172:175], v2 offset:24576
  s_waitcnt vmcnt(12) lgkmcnt(5)
  buffer_load_dwordx4 v[204:207], v1, s[8:11], s44 offen
  s_add_u32 s44, s44, 2048
  v_mfma_f32_16x16x32_bf16 v[136:139], v[176:179], v[24:27], v[136:139]
  buffer_load_dwordx4 v[208:211], v1, s[8:11], s44 offen
  s_add_u32 s44, s44, 2048
  v_mfma_f32_16x16x32_bf16 v[140:143], v[180:183], v[24:27], v[140:143]
  buffer_load_dwordx4 v[212:215], v1, s[8:11], s44 offen
  s_add_u32 s44, s44, 2048
  v_mfma_f32_16x16x32_bf16 v[144:147], v[184:187], v[24:27], v[144:147]
  v_mfma_f32_16x16x32_bf16 v[148:151], v[188:191], v[24:27], v[148:151]
  v_mfma_f32_16x16x32_bf16 v[152:155], v[192:195], v[24:27], v[152:155]
  s_nop 7
  s_cmp_eq_u32 s41, 1
  s_cbranch_scc1 K2_sw1
  ds_write_b128 v8, v[148:151] offset:3072
  ds_write_b128 v8, v[152:155] offset:4096
  s_branch K2_sw2
K2_sw1:
  ds_write_b128 v8, v[136:139] offset:0
  ds_write_b128 v8, v[140:143] offset:1024
  ds_write_b128 v8, v[144:147] offset:2048
K2_sw2:
  s_waitcnt lgkmcnt(0)
  s_barrier
  s_cmp_eq_u32 s41, 1
  s_cbranch_scc1 K2_sr1
  ds_read_b128 v[20:23], v8 offset:0
  ds_read_b128 v[24:27], v8 offset:1024
  ds_read_b128 v[28:31], v8 offset:2048
  s_branch K2_sr2
K2_sr1:
  ds_read_b128 v[32:35], v8 offset:3072
  ds_read_b128 v[36:39], v8 offset:4096
K2_sr2:
  ds_read_b128 v[176:179], v2 offset:30720
  ds_read_b128 v[180:183], v2 offset:31744
  ds_read_b128 v[184:187], v2 offset:32768
  ds_read_b128 v[188:191], v2 offset:33792
  ds_read_b128 v[192:195], v2 offset:34816
  s_waitcnt lgkmcnt(5)
  s_cmp_eq_u32 s41, 1
  s_cbranch_scc1 K2_sa1
  v_add_f32 v136, v136, v20
  v_add_f32 v137, v137, v21
  v_add_f32 v138, v138, v22
  v_add_f32 v139, v139, v23
  v_add_f32 v140, v140, v24
  v_add_f32 v141, v141, v25
  v_add_f32 v142, v142, v26
  v_add_f32 v143, v143, v27
  v_add_f32 v144, v144, v28
  v_add_f32 v145, v145, v29
  v_add_f32 v146, v146, v30
  v_add_f32 v147, v147, v31
  s_branch K2_sa2
K2_sa1:
  v_add_f32 v148, v148, v32
  v_add_f32 v149, v149, v33
  v_add_f32 v150, v150, v34
  v_add_f32 v151, v151, v35
  v_add_f32 v152, v152, v36
  v_add_f32 v153, v153, v37
  v_add_f32 v154, v154, v38
  v_add_f32 v155, v155, v39
K2_sa2:
  s_waitcnt vmcnt(4) lgkmcnt(5)
  buffer_load_dwordx4 v[216:219], v1, s[8:11], s44 offen
  s_add_u32 s44, s44, 2048
  v_mfma_f32_16x16x32_bf16 v[116:119], v[156:159], v[196:199], 0
  v_mfma_f32_16x16x32_bf16 v[120:123], v[160:163], v[196:199], 0
  v_mfma_f32_16x16x32_bf16 v[124:127], v[164:167], v[196:199], 0
  v_mfma_f32_16x16x32_bf16 v[128:131], v[168:171], v[196:199], 0
  v_mfma_f32_16x16x32_bf16 v[132:135], v[172:175], v[196:199], 0
  ds_read_b128 v[156:159], v2 offset:40960
  ds_read_b128 v[160:163], v2 offset:41984
  ds_read_b128 v[164:167], v2 offset:43008
  ds_read_b128 v[168:171], v2 offset:44032
  ds_read_b128 v[172:175], v2 offset:45056
  s_waitcnt vmcnt(4) lgkmcnt(5)
  buffer_load_dwordx4 v[220:223], v1, s[8:11], s44 offen
  s_add_u32 s44, s44, 2048
  v_mfma_f32_16x16x32_bf16 v[116:119], v[176:179], v[200:203], v[116:119]
  v_mfma_f32_16x16x32_bf16 v[120:123], v[180:183], v[200:203], v[120:123]
  v_mfma_f32_16x16x32_bf16 v[124:127], v[184:187], v[200:203], v[124:127]
  v_mfma_f32_16x16x32_bf16 v[128:131], v[188:191], v[200:203], v[128:131]
  v_mfma_f32_16x16x32_bf16 v[132:135], v[192:195], v[200:203], v[132:135]
  ds_read_b128 v[176:179], v2 offset:51200
  ds_read_b128 v[180:183], v2 offset:52224
  ds_read_b128 v[184:187], v2 offset:53248
  ds_read_b128 v[188:191], v2 offset:54272
  ds_read_b128 v[192:195], v2 offset:55296
  s_waitcnt vmcnt(4) lgkmcnt(5)
  buffer_load_dwordx4 v[224:227], v1, s[8:11], s44 offen
  s_add_u32 s44, s44, 2048
  v_mfma_f32_16x16x32_bf16 v[116:119], v[156:159], v[204:207], v[116:119]
  v_mfma_f32_16x16x32_bf16 v[120:123], v[160:163], v[204:207], v[120:123]
  v_mfma_f32_16x16x32_bf16 v[124:127], v[164:167], v[204:207], v[124:127]
  v_mfma_f32_16x16x32_bf16 v[128:131], v[168:171], v[204:207], v[128:131]
  v_mfma_f32_16x16x32_bf16 v[132:135], v[172:175], v[204:207], v[132:135]
  s_waitcnt vmcnt(8)
  s_barrier
  ds_read_b128 v[156:159], v2 offset:61440
  ds_read_b128 v[160:163], v2 offset:62464
  ds_read_b128 v[164:167], v2 offset:63488
  ds_read_b128 v[168:171], v2 offset:64512
  ds_read_b128 v[172:175], v3 offset:0
  s_waitcnt vmcnt(4) lgkmcnt(5)
  buffer_load_dwordx4 v[228:231], v1, s[8:11], s44 offen
  s_add_u32 s44, s44, 2048
  v_mfma_f32_16x16x32_bf16 v[116:119], v[176:179], v[208:211], v[116:119]
  v_mfma_f32_16x16x32_bf16 v[120:123], v[180:183], v[208:211], v[120:123]
  v_mfma_f32_16x16x32_bf16 v[124:127], v[184:187], v[208:211], v[124:127]
  v_mfma_f32_16x16x32_bf16 v[128:131], v[188:191], v[208:211], v[128:131]
  v_mfma_f32_16x16x32_bf16 v[132:135], v[192:195], v[208:211], v[132:135]
  ds_read_b128 v[176:179], v3 offset:6144
  ds_read_b128 v[180:183], v3 offset:7168
  ds_read_b128 v[184:187], v3 offset:8192
  ds_read_b128 v[188:191], v3 offset:9216
  ds_read_b128 v[192:195], v3 offset:10240
  s_waitcnt vmcnt(4) lgkmcnt(5)
  buffer_load_dwordx4 v[232:235], v1, s[8:11], s44 offen
  s_add_u32 s44, s44, 2048
  v_mfma_f32_16x16x32_bf16 v[116:119], v[156:159], v[212:215], v[116:119]
  v_mfma_f32_16x16x32_bf16 v[120:123], v[160:163], v[212:215], v[120:123]
  v_mfma_f32_16x16x32_bf16 v[124:127], v[164:167], v[212:215], v[124:127]
  v_mfma_f32_16x16x32_bf16 v[128:131], v[168:171], v[212:215], v[128:131]
  v_mfma_f32_16x16x32_bf16 v[132:135], v[172:175], v[212:215], v[132:135]
  ds_read_b128 v[156:159], v3 offset:16384
  ds_read_b128 v[160:163], v3 offset:17408
  ds_read_b128 v[164:167], v3 offset:18432
  ds_read_b128 v[168:171], v3 offset:19456
  ds_read_b128 v[172:175], v3 offset:20480
  s_waitcnt vmcnt(4) lgkmcnt(5)
  buffer_load_dwordx4 v[12:15], v6, s[16:19], 0 offen
  v_mfma_f32_16x16x32_bf16 v[116:119], v[176:179], v[216:219], v[116:119]
  buffer_load_dwordx2 v[16:17], v7, s[16:19], 0 offen
  v_mfma_f32_16x16x32_bf16 v[120:123], v[180:183], v[216:219], v[120:123]
  buffer_load_dwordx4 v[236:239], v1, s[8:11], s44 offen
  s_add_u32 s44, s44, 2048
  v_mfma_f32_16x16x32_bf16 v[124:127], v[184:187], v[216:219], v[124:127]
  v_mfma_f32_16x16x32_bf16 v[128:131], v[188:191], v[216:219], v[128:131]
  v_mfma_f32_16x16x32_bf16 v[132:135], v[192:195], v[216:219], v[132:135]
  ds_read_b128 v[176:179], v3 offset:26624
  ds_read_b128 v[180:183], v3 offset:27648
  ds_read_b128 v[184:187], v3 offset:28672
  ds_read_b128 v[188:191], v3 offset:29696
  ds_read_b128 v[192:195], v3 offset:30720
  s_waitcnt vmcnt(6) lgkmcnt(5)
  buffer_load_dwordx4 v[240:243], v1, s[8:11], s44 offen
  s_add_u32 s44, s44, 2048
  v_mfma_f32_16x16x32_bf16 v[116:119], v[156:159], v[220:223], v[116:119]
  v_mfma_f32_16x16x32_bf16 v[120:123], v[160:163], v[220:223], v[120:123]
  v_mfma_f32_16x16x32_bf16 v[124:127], v[164:167], v[220:223], v[124:127]
  v_mfma_f32_16x16x32_bf16 v[128:131], v[168:171], v[220:223], v[128:131]
  v_mfma_f32_16x16x32_bf16 v[132:135], v[172:175], v[220:223], v[132:135]
  ds_read_b128 v[156:159], v3 offset:36864
  ds_read_b128 v[160:163], v3 offset:37888
  ds_read_b128 v[164:167], v3 offset:38912
  ds_read_b128 v[168:171], v3 offset:39936
  ds_read_b128 v[172:175], v3 offset:40960
  s_waitcnt vmcnt(6) lgkmcnt(5)
  buffer_load_dwordx4 v[244:247], v1, s[8:11], s44 offen
  s_add_u32 s44, s44, 2048
  v_mfma_f32_16x16x32_bf16 v[116:119], v[176:179], v[224:227], v[116:119]
  v_mfma_f32_16x16x32_bf16 v[120:123], v[180:183], v[224:227], v[120:123]
  v_mfma_f32_16x16x32_bf16 v[124:127], v[184:187], v[224:227], v[124:127]
  v_mfma_f32_16x16x32_bf16 v[128:131], v[188:191], v[224:227], v[128:131]
  v_mfma_f32_16x16x32_bf16 v[132:135], v[192:195], v[224:227], v[132:135]
  ds_read_b128 v[176:179], v3 offset:47104
  ds_read_b128 v[180:183], v3 offset:48128
  ds_read_b128 v[184:187], v3 offset:49152
  ds_read_b128 v[188:191], v3 offset:50176
  ds_read_b128 v[192:195], v3 offset:51200
  s_waitcnt vmcnt(6) lgkmcnt(5)
  buffer_load_dwordx4 v[248:251], v1, s[8:11], s44 offen
  s_add_u32 s44, s44, 2048
  v_mfma_f32_16x16x32_bf16 v[116:119], v[156:159], v[228:231], v[116:119]
  v_mfma_f32_16x16x32_bf16 v[120:123], v[160:163], v[228:231], v[120:123]
  v_mfma_f32_16x16x32_bf16 v[124:127], v[164:167], v[228:231], v[124:127]
  v_mfma_f32_16x16x32_bf16 v[128:131], v[168:171], v[228:231], v[128:131]
  v_mfma_f32_16x16x32_bf16 v[132:135], v[172:175], v[228:231], v[132:135]
  ds_read_b128 v[156:159], v3 offset:57344
  ds_read_b128 v[160:163], v3 offset:58368
  ds_read_b128 v[164:167], v3 offset:59392
  ds_read_b128 v[168:171], v3 offset:60416
  ds_read_b128 v[172:175], v3 offset:61440
  s_waitcnt vmcnt(6) lgkmcnt(5)
  v_mfma_f32_16x16x32_bf16 v[116:119], v[176:179], v[232:235], v[116:119]
  v_mfma_f32_16x16x32_bf16 v[120:123], v[180:183], v[232:235], v[120:123]
  v_mfma_f32_16x16x32_bf16 v[124:127], v[184:187], v[232:235], v[124:127]
  v_mfma_f32_16x16x32_bf16 v[128:131], v[188:191], v[232:235], v[128:131]
  v_mfma_f32_16x16x32_bf16 v[132:135], v[192:195], v[232:235], v[132:135]
  ds_read_b128 v[176:179], v4 offset:2048
  ds_read_b128 v[180:183], v4 offset:3072
  ds_read_b128 v[184:187], v4 offset:4096
  ds_read_b128 v[188:191], v4 offset:5120
  ds_read_b128 v[192:195], v4 offset:6144
  s_waitcnt vmcnt(3) lgkmcnt(5)
  v_mfma_f32_16x16x32_bf16 v[116:119], v[156:159], v[236:239], v[116:119]
  v_mfma_f32_16x16x32_bf16 v[120:123], v[160:163], v[236:239], v[120:123]
  v_mfma_f32_16x16x32_bf16 v[124:127], v[164:167], v[236:239], v[124:127]
  v_mfma_f32_16x16x32_bf16 v[128:131], v[168:171], v[236:239], v[128:131]
  v_mfma_f32_16x16x32_bf16 v[132:135], v[172:175], v[236:239], v[132:135]
  v_permlane16_swap_b32 v12, v14
  v_permlane16_swap_b32 v13, v15
  v_lshlrev_b32 v80, 16, v12
  v_and_b32 v81, 0xffff0000, v12
  v_lshlrev_b32 v82, 16, v13
  v_and_b32 v83, 0xffff0000, v13
  v_lshlrev_b32 v84, 16, v14
  v_and_b32 v85, 0xffff0000, v14
  v_lshlrev_b32 v86, 16, v15
  v_and_b32 v87, 0xffff0000, v15
  v_lshlrev_b32 v88, 16, v16
  v_and_b32 v89, 0xffff0000, v16
  v_lshlrev_b32 v90, 16, v17
  v_and_b32 v91, 0xffff0000, v17
  ds_read_b128 v[156:159], v4 offset:12288
  ds_read_b128 v[160:163], v4 offset:13312
  ds_read_b128 v[164:167], v4 offset:14336
  ds_read_b128 v[168:171], v4 offset:15360
  ds_read_b128 v[172:175], v4 offset:16384
  s_waitcnt vmcnt(2) lgkmcnt(5)
  v_mfma_f32_16x16x32_bf16 v[116:119], v[176:179], v[240:243], v[116:119]
  v_mfma_f32_16x16x32_bf16 v[120:123], v[180:183], v[240:243], v[120:123]
  v_mfma_f32_16x16x32_bf16 v[124:127], v[184:187], v[240:243], v[124:127]
  v_mfma_f32_16x16x32_bf16 v[128:131], v[188:191], v[240:243], v[128:131]
  v_mfma_f32_16x16x32_bf16 v[132:135], v[192:195], v[240:243], v[132:135]
  ds_read_b128 v[176:179], v4 offset:22528
  ds_read_b128 v[180:183], v4 offset:23552
  ds_read_b128 v[184:187], v4 offset:24576
  ds_read_b128 v[188:191], v4 offset:25600
  ds_read_b128 v[192:195], v4 offset:26624
  s_waitcnt vmcnt(1) lgkmcnt(5)
  v_mfma_f32_16x16x32_bf16 v[116:119], v[156:159], v[244:247], v[116:119]
  v_mfma_f32_16x16x32_bf16 v[120:123], v[160:163], v[244:247], v[120:123]
  v_mfma_f32_16x16x32_bf16 v[124:127], v[164:167], v[244:247], v[124:127]
  v_mfma_f32_16x16x32_bf16 v[128:131], v[168:171], v[244:247], v[128:131]
  v_mfma_f32_16x16x32_bf16 v[132:135], v[172:175], v[244:247], v[132:135]
  s_waitcnt vmcnt(0) lgkmcnt(0)
  s_cmp_eq_u32 s41, 1
  s_cbranch_scc1 K2_skipm
  v_mfma_f32_16x16x32_bf16 v[116:119], v[176:179], v[248:251], v[116:119]
  v_mfma_f32_16x16x32_bf16 v[120:123], v[180:183], v[248:251], v[120:123]
  v_mfma_f32_16x16x32_bf16 v[124:127], v[184:187], v[248:251], v[124:127]
  v_mfma_f32_16x16x32_bf16 v[128:131], v[188:191], v[248:251], v[128:131]
  v_mfma_f32_16x16x32_bf16 v[132:135], v[192:195], v[248:251], v[132:135]
K2_skipm:
  s_nop 7
  s_cmp_eq_u32 s41, 1
  s_cbranch_scc1 K2_yw1
  ds_write_b128 v8, v[128:131] offset:23552
  ds_write_b128 v8, v[132:135] offset:24576
  s_branch K2_yw2
K2_yw1:
  ds_write_b128 v8, v[116:119] offset:20480
  ds_write_b128 v8, v[120:123] offset:21504
  ds_write_b128 v8, v[124:127] offset:22528
K2_yw2:
  s_mov_b32 s52, 0xbfb8aa3b
  s_mov_b32 s53, 0xbfb8aa3b
  s_mov_b32 s48, 1.0
  s_mov_b32 s49, 1.0
  s_waitcnt lgkmcnt(0)
  s_barrier
  s_cmp_eq_u32 s41, 1
  s_cbranch_scc1 K2_fin1
  ds_read_b128 v[156:159], v8 offset:20480
  ds_read_b128 v[160:163], v8 offset:21504
  ds_read_b128 v[164:167], v8 offset:22528
  s_waitcnt lgkmcnt(1)
  v_pk_add_f32 v[116:117], v[116:117], v[156:157]
  v_pk_add_f32 v[118:119], v[118:119], v[158:159]
  v_pk_add_f32 v[120:121], v[120:121], v[160:161]
  v_pk_add_f32 v[122:123], v[122:123], v[162:163]
  v_pk_mul_f32 v[168:169], v[116:117], s[52:53]
  v_pk_mul_f32 v[170:171], v[118:119], s[52:53]
  v_pk_mul_f32 v[172:173], v[120:121], s[52:53]
  v_pk_mul_f32 v[174:175], v[122:123], s[52:53]
  v_exp_f32 v168, v168
  v_exp_f32 v169, v169
  v_exp_f32 v170, v170
  v_exp_f32 v171, v171
  v_exp_f32 v172, v172
  v_exp_f32 v173, v173
  v_exp_f32 v174, v174
  v_exp_f32 v175, v175
  v_pk_add_f32 v[168:169], v[168:169], s[48:49]
  v_pk_add_f32 v[170:171], v[170:171], s[48:49]
  v_pk_add_f32 v[172:173], v[172:173], s[48:49]
  v_pk_add_f32 v[174:175], v[174:175], s[48:49]
  v_rcp_f32 v168, v168
  v_rcp_f32 v169, v169
  v_rcp_f32 v170, v170
  v_rcp_f32 v171, v171
  v_rcp_f32 v172, v172
  v_rcp_f32 v173, v173
  v_rcp_f32 v174, v174
  v_rcp_f32 v175, v175
  v_pk_mul_f32 v[168:169], v[168:169], v[116:117]
  v_pk_mul_f32 v[170:171], v[170:171], v[118:119]
  v_pk_mul_f32 v[172:173], v[172:173], v[120:121]
  v_pk_mul_f32 v[174:175], v[174:175], v[122:123]
  v_pk_fma_f32 v[168:169], v[168:169], v[136:137], v[80:81]
  v_pk_fma_f32 v[170:171], v[170:171], v[138:139], v[82:83]
  v_pk_fma_f32 v[172:173], v[172:173], v[140:141], v[84:85]
  v_pk_fma_f32 v[174:175], v[174:175], v[142:143], v[86:87]
  v_cvt_pk_bf16_f32 v20, v168, v169
  v_cvt_pk_bf16_f32 v21, v170, v171
  v_cvt_pk_bf16_f32 v22, v172, v173
  v_cvt_pk_bf16_f32 v23, v174, v175
  s_nop 0
  v_permlane16_swap_b32 v20, v22
  v_permlane16_swap_b32 v21, v23
  buffer_store_dwordx4 v[20:23], v6, s[20:23], 0 offen sc1
  s_waitcnt lgkmcnt(0)
  v_pk_add_f32 v[124:125], v[124:125], v[164:165]
  v_pk_add_f32 v[126:127], v[126:127], v[166:167]
  v_pk_mul_f32 v[176:177], v[124:125], s[52:53]
  v_pk_mul_f32 v[178:179], v[126:127], s[52:53]
  v_exp_f32 v176, v176
  v_exp_f32 v177, v177
  v_exp_f32 v178, v178
  v_exp_f32 v179, v179
  v_pk_add_f32 v[176:177], v[176:177], s[48:49]
  v_pk_add_f32 v[178:179], v[178:179], s[48:49]
  v_rcp_f32 v176, v176
  v_rcp_f32 v177, v177
  v_rcp_f32 v178, v178
  v_rcp_f32 v179, v179
  v_pk_mul_f32 v[176:177], v[176:177], v[124:125]
  v_pk_mul_f32 v[178:179], v[178:179], v[126:127]
  v_pk_fma_f32 v[176:177], v[176:177], v[144:145], v[88:89]
  v_pk_fma_f32 v[178:179], v[178:179], v[146:147], v[90:91]
  v_cvt_pk_bf16_f32 v24, v176, v177
  v_cvt_pk_bf16_f32 v25, v178, v179
  buffer_store_dwordx2 v[24:25], v7, s[20:23], 0 offen sc1
  s_branch K2_fin
K2_fin1:
  ds_read_b128 v[156:159], v8 offset:23552
  ds_read_b128 v[160:163], v8 offset:24576
  s_waitcnt lgkmcnt(0)
  v_pk_add_f32 v[128:129], v[128:129], v[156:157]
  v_pk_add_f32 v[130:131], v[130:131], v[158:159]
  v_pk_add_f32 v[132:133], v[132:133], v[160:161]
  v_pk_add_f32 v[134:135], v[134:135], v[162:163]
  v_pk_mul_f32 v[168:169], v[128:129], s[52:53]
  v_pk_mul_f32 v[170:171], v[130:131], s[52:53]
  v_pk_mul_f32 v[172:173], v[132:133], s[52:53]
  v_pk_mul_f32 v[174:175], v[134:135], s[52:53]
  v_exp_f32 v168, v168
  v_exp_f32 v169, v169
  v_exp_f32 v170, v170
  v_exp_f32 v171, v171
  v_exp_f32 v172, v172
  v_exp_f32 v173, v173
  v_exp_f32 v174, v174
  v_exp_f32 v175, v175
  v_pk_add_f32 v[168:169], v[168:169], s[48:49]
  v_pk_add_f32 v[170:171], v[170:171], s[48:49]
  v_pk_add_f32 v[172:173], v[172:173], s[48:49]
  v_pk_add_f32 v[174:175], v[174:175], s[48:49]
  v_rcp_f32 v168, v168
  v_rcp_f32 v169, v169
  v_rcp_f32 v170, v170
  v_rcp_f32 v171, v171
  v_rcp_f32 v172, v172
  v_rcp_f32 v173, v173
  v_rcp_f32 v174, v174
  v_rcp_f32 v175, v175
  v_pk_mul_f32 v[168:169], v[168:169], v[128:129]
  v_pk_mul_f32 v[170:171], v[170:171], v[130:131]
  v_pk_mul_f32 v[172:173], v[172:173], v[132:133]
  v_pk_mul_f32 v[174:175], v[174:175], v[134:135]
  v_pk_fma_f32 v[168:169], v[168:169], v[148:149], v[80:81]
  v_pk_fma_f32 v[170:171], v[170:171], v[150:151], v[82:83]
  v_pk_fma_f32 v[172:173], v[172:173], v[152:153], v[84:85]
  v_pk_fma_f32 v[174:175], v[174:175], v[154:155], v[86:87]
  v_cvt_pk_bf16_f32 v20, v168, v169
  v_cvt_pk_bf16_f32 v21, v170, v171
  v_cvt_pk_bf16_f32 v22, v172, v173
  v_cvt_pk_bf16_f32 v23, v174, v175
  s_nop 0
  v_permlane16_swap_b32 v20, v22
  v_permlane16_swap_b32 v21, v23
  buffer_store_dwordx4 v[20:23], v6, s[20:23], 0 offen sc1
K2_fin:
  s_branch K2_done
K2_ospin:
  s_mov_b32 s55, 100000
  s_add_u32 s33, s54, 4096
K2_ospin_l:
  buffer_load_dwordx2 v[54:55], v56, s[8:11], s33 offen sc1
  s_waitcnt vmcnt(0)
  v_cmp_ne_u32 vcc, s52, v54
  s_nop 3
  s_mov_b64 s[48:49], vcc
  v_cmp_ne_u32 vcc, s53, v55
  s_nop 3
  s_or_b64 s[48:49], s[48:49], vcc
  s_cmp_eq_u64 s[48:49], 0
  s_cbranch_scc1 K2_ook
  s_sub_u32 s55, s55, 1
  s_cmp_lg_u32 s55, 0
  s_cbranch_scc1 K2_ospin_l
  s_branch K2_ook
K2_fspin:
  s_mov_b32 s55, 100000
  buffer_load_dwordx2 v[80:81], v56, s[8:11], s54 offen sc1
  buffer_load_dwordx2 v[82:83], v56, s[8:11], s54 offen sc1
  buffer_load_dwordx2 v[84:85], v56, s[8:11], s54 offen sc1
K2_fspin_l:
  buffer_load_dwordx2 v[86:87], v56, s[8:11], s54 offen sc1
  s_waitcnt vmcnt(3)
  v_cmp_ne_u32 vcc, s52, v80
  s_nop 3
  s_mov_b64 s[48:49], vcc
  v_cmp_ne_u32 vcc, s53, v81
  s_nop 3
  s_or_b64 s[48:49], s[48:49], vcc
  s_cmp_eq_u64 s[48:49], 0
  s_cbranch_scc1 K2_fexit
  buffer_load_dwordx2 v[80:81], v56, s[8:11], s54 offen sc1
  s_waitcnt vmcnt(3)
  v_cmp_ne_u32 vcc, s52, v82
  s_nop 3
  s_mov_b64 s[48:49], vcc
  v_cmp_ne_u32 vcc, s53, v83
  s_nop 3
  s_or_b64 s[48:49], s[48:49], vcc
  s_cmp_eq_u64 s[48:49], 0
  s_cbranch_scc1 K2_fexit
  buffer_load_dwordx2 v[82:83], v56, s[8:11], s54 offen sc1
  s_waitcnt vmcnt(3)
  v_cmp_ne_u32 vcc, s52, v84
  s_nop 3
  s_mov_b64 s[48:49], vcc
  v_cmp_ne_u32 vcc, s53, v85
  s_nop 3
  s_or_b64 s[48:49], s[48:49], vcc
  s_cmp_eq_u64 s[48:49], 0
  s_cbranch_scc1 K2_fexit
  buffer_load_dwordx2 v[84:85], v56, s[8:11], s54 offen sc1
  s_waitcnt vmcnt(3)
  v_cmp_ne_u32 vcc, s52, v86
  s_nop 3
  s_mov_b64 s[48:49], vcc
  v_cmp_ne_u32 vcc, s53, v87
  s_nop 3
  s_or_b64 s[48:49], s[48:49], vcc
  s_cmp_eq_u64 s[48:49], 0
  s_cbranch_scc1 K2_fexit
  s_sub_u32 s55, s55, 1
  s_cmp_lg_u32 s55, 0
  s_cbranch_scc1 K2_fspin_l
K2_fexit:
  s_branch K2_fok
K2_done:
k2_kernel_end:
  s_endpgm
.section .rodata,"a"
.p2align 6
.amdhsa_kernel k2_kernel
  .amdhsa_next_free_vgpr 256
  .amdhsa_next_free_sgpr 102
  .amdhsa_accum_offset 256
  .amdhsa_group_segment_fixed_size 0
  .amdhsa_kernarg_size 88
  .amdhsa_user_sgpr_count 2
  .amdhsa_user_sgpr_kernarg_segment_ptr 1
  .amdhsa_system_sgpr_workgroup_id_x 1
.end_amdhsa_kernel
.text
```
